```python
import torch

def _softmax(x, axis=-1):
    return torch.softmax(x, dim=axis)
def _gelu(x):
    return torch.nn.functional.gelu(x, approximate="tanh")
def _silu(x):
    return torch.nn.functional.silu(x)
def _sigmoid(x):
    return torch.sigmoid(x)
def _layernorm(x, axis=-1, eps=1e-5):
    m = x.mean(dim=axis, keepdim=True)
    v = x.var(dim=axis, keepdim=True, unbiased=False)
    return (x - m) / torch.sqrt(v + eps)
def _scatter_add(tgt, idx, src, axis=0):
    return tgt.clone().index_add_(axis, idx, src)
def _segment_sum(src, seg, n):
    out = torch.zeros((n,) + src.shape[1:], dtype=src.dtype)
    return out.index_add_(0, seg, src)
def _pad(x, pw):
    flat = tuple(v for pair in reversed(pw) for v in pair)
    return torch.nn.functional.pad(x, flat)

kernel_name = 'standalone__groupnorm__prompt'

def setup_inputs():

    _w = (lambda a: (lambda t: t.to(torch.bfloat16) if t.is_floating_point() else t)(torch.as_tensor(a)))
    B = 2
    G = 32
    cpg = max(1, 576 // G)
    C = G * cpg
    H, W = 32, 2048
    return {
        "x": _w(abs((lambda *s: torch.randn(*s, dtype=torch.bfloat16) * 0.05)(B, C, H, W))),
        "g": _w((lambda *s: torch.randn(*s, dtype=torch.bfloat16) * 0.05)(C) + 1.0),
        "b": _w((lambda *s: torch.randn(*s, dtype=torch.bfloat16) * 0.4)(C)),
    }

def reference(x, g, b):
    G = 32
    B, C, H, W = x.shape[0], x.shape[1], x.shape[2], x.shape[3]
    xr = x.reshape(B, G, C // G, H, W)
    mu = xr.mean(axis=(2, 3, 4), keepdims=True)
    var = ((xr - mu) ** 2).mean(axis=(2, 3, 4), keepdims=True)
    xn = (xr - mu) / torch.sqrt(var + 1e-5)
    xn = xn.reshape(B, C, H, W)
    return xn * g[None, :, None, None] + b[None, :, None, None]
```

```asm
; @launch grid=(256,1,1) block=(512,1,1) lds=147712
.amdgcn_target "amdgcn-amd-amdhsa--gfx950"
.text
.globl standalone__groupnorm__prompt_kernel
.p2align 8
.type standalone__groupnorm__prompt_kernel,@function
standalone__groupnorm__prompt_kernel:
    s_load_dwordx2 s[4:5], s[0:1], 0
    s_cmp_ge_u32 s2, 256
    s_cbranch_scc1 L_end
    v_lshlrev_b32 v12, 4, v0
    s_lshr_b32 s24, s2, 3
    v_readfirstlane_b32 s26, v12
    s_and_b32 s25, s2, 7
    s_mul_i32 s28, s24, 2359296
    s_lshl_b32 s41, s25, 14
    s_add_u32 s40, s41, s26
    v_add_u32 v0, s40, v12
    s_mul_i32 m0, s26, 18
    s_mov_b32 s6, 150994944
    s_mov_b32 s7, 0x20000
    s_mov_b32 s27, s28
    s_add_u32 s29, s28, 1179648
    s_getreg_b32 s64, hwreg(HW_REG_XCC_ID)
    v_mov_b32 v8, 0
    v_mov_b32 v9, 0
    v_mov_b32 v10, 0
    v_mov_b32 v11, 0
    v_add_u32 v2, 147456, v12
    v_cmp_gt_u32 vcc, 256, v12
    s_and_saveexec_b64 s[58:59], vcc
    ds_write_b128 v2, v[8:11]
    s_mov_b64 exec, -1
    s_waitcnt lgkmcnt(0)
    s_barrier
L_ldsloop:
    buffer_load_dwordx4 v0, s[4:7], s27 offen nt lds
    buffer_load_dwordx4 v0, s[4:7], s27 offen offset:1024 nt lds
    s_add_u32 s27, s27, 131072
    s_add_u32 m0, m0, 2048
    s_cmp_lt_u32 s27, s29
    s_cbranch_scc1 L_ldsloop
    s_load_dwordx4 s[44:47], s[0:1], 8
    s_load_dwordx2 s[8:9], s[0:1], 24
    s_load_dwordx2 s[12:13], s[0:1], 40
    s_add_u32 s29, s28, 75497472
    s_load_dword s30, s[4:5], s28
    s_load_dword s32, s[4:5], s29
    s_lshr_b32 s26, s26, 10
    v_and_b32 v12, 0x3ff, v12
    s_mul_i32 s43, s26, 18432
    v_lshrrev_b32 v13, 3, v12
    v_add_u32 v2, s43, v12
    s_mul_i32 s41, s24, 36
    s_lshl_b32 s54, s24, 7
    s_lshl_b32 s55, s24, 8
    s_add_u32 s55, s55, 4096
    s_lshl_b32 s56, s25, 4
    s_add_u32 s56, s56, s55
    s_mov_b32 s42, 0xffff0000
    s_mov_b32 s10, 150994944
    s_mov_b32 s11, 0x20000
    s_mov_b32 s14, 12288
    s_mov_b32 s15, 0x20000
    s_mov_b32 s18, 1152
    s_mov_b32 s19, 0x20000
    s_mov_b32 s22, 1152
    s_mov_b32 s23, 0x20000
    s_and_b32 s64, s64, 1
    s_waitcnt lgkmcnt(0)
    s_mov_b32 s16, s44
    s_mov_b32 s17, s45
    s_mov_b32 s20, s46
    s_mov_b32 s21, s47
    s_lshl_b32 s30, s30, 16
    s_lshl_b32 s32, s32, 16
    buffer_load_dword v4, off, s[12:15], s54 sc1
    buffer_load_ushort v3, v13, s[16:19], s41 offen
    buffer_load_ushort v5, v13, s[20:23], s41 offen
    v_mov_b32 v8, 0
    v_mov_b32 v9, 0
    v_mov_b32 v10, 0
    v_mov_b32 v11, 0
    s_waitcnt vmcnt(20)
    ds_read_b128 v[16:19], v2 offset:0
    s_waitcnt lgkmcnt(0)
    v_lshlrev_b32 v12, 16, v16
    v_and_b32 v13, s42, v16
    v_lshlrev_b32 v14, 16, v17
    v_and_b32 v15, s42, v17
    v_lshlrev_b32 v16, 16, v18
    v_and_b32 v17, s42, v18
    v_lshlrev_b32 v18, 16, v19
    v_and_b32 v19, s42, v19
    v_pk_add_f32 v[12:13], v[12:13], s[30:31] op_sel_hi:[1,0] neg_lo:[0,1] neg_hi:[0,1]
    v_pk_add_f32 v[14:15], v[14:15], s[30:31] op_sel_hi:[1,0] neg_lo:[0,1] neg_hi:[0,1]
    v_pk_add_f32 v[16:17], v[16:17], s[30:31] op_sel_hi:[1,0] neg_lo:[0,1] neg_hi:[0,1]
    v_pk_add_f32 v[18:19], v[18:19], s[30:31] op_sel_hi:[1,0] neg_lo:[0,1] neg_hi:[0,1]
    v_pk_add_f32 v[8:9], v[8:9], v[12:13]
    v_pk_fma_f32 v[10:11], v[12:13], v[12:13], v[10:11]
    v_pk_add_f32 v[8:9], v[8:9], v[14:15]
    v_pk_fma_f32 v[10:11], v[14:15], v[14:15], v[10:11]
    v_pk_add_f32 v[8:9], v[8:9], v[16:17]
    v_pk_fma_f32 v[10:11], v[16:17], v[16:17], v[10:11]
    v_pk_add_f32 v[8:9], v[8:9], v[18:19]
    v_pk_fma_f32 v[10:11], v[18:19], v[18:19], v[10:11]
    s_waitcnt vmcnt(19)
    ds_read_b128 v[16:19], v2 offset:1024
    s_waitcnt lgkmcnt(0)
    v_lshlrev_b32 v12, 16, v16
    v_and_b32 v13, s42, v16
    v_lshlrev_b32 v14, 16, v17
    v_and_b32 v15, s42, v17
    v_lshlrev_b32 v16, 16, v18
    v_and_b32 v17, s42, v18
    v_lshlrev_b32 v18, 16, v19
    v_and_b32 v19, s42, v19
    v_pk_add_f32 v[12:13], v[12:13], s[30:31] op_sel_hi:[1,0] neg_lo:[0,1] neg_hi:[0,1]
    v_pk_add_f32 v[14:15], v[14:15], s[30:31] op_sel_hi:[1,0] neg_lo:[0,1] neg_hi:[0,1]
    v_pk_add_f32 v[16:17], v[16:17], s[30:31] op_sel_hi:[1,0] neg_lo:[0,1] neg_hi:[0,1]
    v_pk_add_f32 v[18:19], v[18:19], s[30:31] op_sel_hi:[1,0] neg_lo:[0,1] neg_hi:[0,1]
    v_pk_add_f32 v[8:9], v[8:9], v[12:13]
    v_pk_fma_f32 v[10:11], v[12:13], v[12:13], v[10:11]
    v_pk_add_f32 v[8:9], v[8:9], v[14:15]
    v_pk_fma_f32 v[10:11], v[14:15], v[14:15], v[10:11]
    v_pk_add_f32 v[8:9], v[8:9], v[16:17]
    v_pk_fma_f32 v[10:11], v[16:17], v[16:17], v[10:11]
    v_pk_add_f32 v[8:9], v[8:9], v[18:19]
    v_pk_fma_f32 v[10:11], v[18:19], v[18:19], v[10:11]
    s_waitcnt vmcnt(18)
    ds_read_b128 v[16:19], v2 offset:2048
    s_waitcnt lgkmcnt(0)
    v_lshlrev_b32 v12, 16, v16
    v_and_b32 v13, s42, v16
    v_lshlrev_b32 v14, 16, v17
    v_and_b32 v15, s42, v17
    v_lshlrev_b32 v16, 16, v18
    v_and_b32 v17, s42, v18
    v_lshlrev_b32 v18, 16, v19
    v_and_b32 v19, s42, v19
    v_pk_add_f32 v[12:13], v[12:13], s[30:31] op_sel_hi:[1,0] neg_lo:[0,1] neg_hi:[0,1]
    v_pk_add_f32 v[14:15], v[14:15], s[30:31] op_sel_hi:[1,0] neg_lo:[0,1] neg_hi:[0,1]
    v_pk_add_f32 v[16:17], v[16:17], s[30:31] op_sel_hi:[1,0] neg_lo:[0,1] neg_hi:[0,1]
    v_pk_add_f32 v[18:19], v[18:19], s[30:31] op_sel_hi:[1,0] neg_lo:[0,1] neg_hi:[0,1]
    v_pk_add_f32 v[8:9], v[8:9], v[12:13]
    v_pk_fma_f32 v[10:11], v[12:13], v[12:13], v[10:11]
    v_pk_add_f32 v[8:9], v[8:9], v[14:15]
    v_pk_fma_f32 v[10:11], v[14:15], v[14:15], v[10:11]
    v_pk_add_f32 v[8:9], v[8:9], v[16:17]
    v_pk_fma_f32 v[10:11], v[16:17], v[16:17], v[10:11]
    v_pk_add_f32 v[8:9], v[8:9], v[18:19]
    v_pk_fma_f32 v[10:11], v[18:19], v[18:19], v[10:11]
    s_waitcnt vmcnt(17)
    ds_read_b128 v[16:19], v2 offset:3072
    s_waitcnt lgkmcnt(0)
    v_lshlrev_b32 v12, 16, v16
    v_and_b32 v13, s42, v16
    v_lshlrev_b32 v14, 16, v17
    v_and_b32 v15, s42, v17
    v_lshlrev_b32 v16, 16, v18
    v_and_b32 v17, s42, v18
    v_lshlrev_b32 v18, 16, v19
    v_and_b32 v19, s42, v19
    v_pk_add_f32 v[12:13], v[12:13], s[30:31] op_sel_hi:[1,0] neg_lo:[0,1] neg_hi:[0,1]
    v_pk_add_f32 v[14:15], v[14:15], s[30:31] op_sel_hi:[1,0] neg_lo:[0,1] neg_hi:[0,1]
    v_pk_add_f32 v[16:17], v[16:17], s[30:31] op_sel_hi:[1,0] neg_lo:[0,1] neg_hi:[0,1]
    v_pk_add_f32 v[18:19], v[18:19], s[30:31] op_sel_hi:[1,0] neg_lo:[0,1] neg_hi:[0,1]
    v_pk_add_f32 v[8:9], v[8:9], v[12:13]
    v_pk_fma_f32 v[10:11], v[12:13], v[12:13], v[10:11]
    v_pk_add_f32 v[8:9], v[8:9], v[14:15]
    v_pk_fma_f32 v[10:11], v[14:15], v[14:15], v[10:11]
    v_pk_add_f32 v[8:9], v[8:9], v[16:17]
    v_pk_fma_f32 v[10:11], v[16:17], v[16:17], v[10:11]
    v_pk_add_f32 v[8:9], v[8:9], v[18:19]
    v_pk_fma_f32 v[10:11], v[18:19], v[18:19], v[10:11]
    s_waitcnt vmcnt(16)
    ds_read_b128 v[16:19], v2 offset:4096
    s_waitcnt lgkmcnt(0)
    v_lshlrev_b32 v12, 16, v16
    v_and_b32 v13, s42, v16
    v_lshlrev_b32 v14, 16, v17
    v_and_b32 v15, s42, v17
    v_lshlrev_b32 v16, 16, v18
    v_and_b32 v17, s42, v18
    v_lshlrev_b32 v18, 16, v19
    v_and_b32 v19, s42, v19
    v_pk_add_f32 v[12:13], v[12:13], s[30:31] op_sel_hi:[1,0] neg_lo:[0,1] neg_hi:[0,1]
    v_pk_add_f32 v[14:15], v[14:15], s[30:31] op_sel_hi:[1,0] neg_lo:[0,1] neg_hi:[0,1]
    v_pk_add_f32 v[16:17], v[16:17], s[30:31] op_sel_hi:[1,0] neg_lo:[0,1] neg_hi:[0,1]
    v_pk_add_f32 v[18:19], v[18:19], s[30:31] op_sel_hi:[1,0] neg_lo:[0,1] neg_hi:[0,1]
    v_pk_add_f32 v[8:9], v[8:9], v[12:13]
    v_pk_fma_f32 v[10:11], v[12:13], v[12:13], v[10:11]
    v_pk_add_f32 v[8:9], v[8:9], v[14:15]
    v_pk_fma_f32 v[10:11], v[14:15], v[14:15], v[10:11]
    v_pk_add_f32 v[8:9], v[8:9], v[16:17]
    v_pk_fma_f32 v[10:11], v[16:17], v[16:17], v[10:11]
    v_pk_add_f32 v[8:9], v[8:9], v[18:19]
    v_pk_fma_f32 v[10:11], v[18:19], v[18:19], v[10:11]
    s_waitcnt vmcnt(15)
    ds_read_b128 v[16:19], v2 offset:5120
    s_waitcnt lgkmcnt(0)
    v_lshlrev_b32 v12, 16, v16
    v_and_b32 v13, s42, v16
    v_lshlrev_b32 v14, 16, v17
    v_and_b32 v15, s42, v17
    v_lshlrev_b32 v16, 16, v18
    v_and_b32 v17, s42, v18
    v_lshlrev_b32 v18, 16, v19
    v_and_b32 v19, s42, v19
    v_pk_add_f32 v[12:13], v[12:13], s[30:31] op_sel_hi:[1,0] neg_lo:[0,1] neg_hi:[0,1]
    v_pk_add_f32 v[14:15], v[14:15], s[30:31] op_sel_hi:[1,0] neg_lo:[0,1] neg_hi:[0,1]
    v_pk_add_f32 v[16:17], v[16:17], s[30:31] op_sel_hi:[1,0] neg_lo:[0,1] neg_hi:[0,1]
    v_pk_add_f32 v[18:19], v[18:19], s[30:31] op_sel_hi:[1,0] neg_lo:[0,1] neg_hi:[0,1]
    v_pk_add_f32 v[8:9], v[8:9], v[12:13]
    v_pk_fma_f32 v[10:11], v[12:13], v[12:13], v[10:11]
    v_pk_add_f32 v[8:9], v[8:9], v[14:15]
    v_pk_fma_f32 v[10:11], v[14:15], v[14:15], v[10:11]
    v_pk_add_f32 v[8:9], v[8:9], v[16:17]
    v_pk_fma_f32 v[10:11], v[16:17], v[16:17], v[10:11]
    v_pk_add_f32 v[8:9], v[8:9], v[18:19]
    v_pk_fma_f32 v[10:11], v[18:19], v[18:19], v[10:11]
    s_waitcnt vmcnt(14)
    ds_read_b128 v[16:19], v2 offset:6144
    s_waitcnt lgkmcnt(0)
    v_lshlrev_b32 v12, 16, v16
    v_and_b32 v13, s42, v16
    v_lshlrev_b32 v14, 16, v17
    v_and_b32 v15, s42, v17
    v_lshlrev_b32 v16, 16, v18
    v_and_b32 v17, s42, v18
    v_lshlrev_b32 v18, 16, v19
    v_and_b32 v19, s42, v19
    v_pk_add_f32 v[12:13], v[12:13], s[30:31] op_sel_hi:[1,0] neg_lo:[0,1] neg_hi:[0,1]
    v_pk_add_f32 v[14:15], v[14:15], s[30:31] op_sel_hi:[1,0] neg_lo:[0,1] neg_hi:[0,1]
    v_pk_add_f32 v[16:17], v[16:17], s[30:31] op_sel_hi:[1,0] neg_lo:[0,1] neg_hi:[0,1]
    v_pk_add_f32 v[18:19], v[18:19], s[30:31] op_sel_hi:[1,0] neg_lo:[0,1] neg_hi:[0,1]
    v_pk_add_f32 v[8:9], v[8:9], v[12:13]
    v_pk_fma_f32 v[10:11], v[12:13], v[12:13], v[10:11]
    v_pk_add_f32 v[8:9], v[8:9], v[14:15]
    v_pk_fma_f32 v[10:11], v[14:15], v[14:15], v[10:11]
    v_pk_add_f32 v[8:9], v[8:9], v[16:17]
    v_pk_fma_f32 v[10:11], v[16:17], v[16:17], v[10:11]
    v_pk_add_f32 v[8:9], v[8:9], v[18:19]
    v_pk_fma_f32 v[10:11], v[18:19], v[18:19], v[10:11]
    buffer_load_dwordx4 v[20:23], v0, s[4:7], s27 offen nt
    s_waitcnt vmcnt(14)
    ds_read_b128 v[16:19], v2 offset:7168
    s_waitcnt lgkmcnt(0)
    v_lshlrev_b32 v12, 16, v16
    v_and_b32 v13, s42, v16
    v_lshlrev_b32 v14, 16, v17
    v_and_b32 v15, s42, v17
    v_lshlrev_b32 v16, 16, v18
    v_and_b32 v17, s42, v18
    v_lshlrev_b32 v18, 16, v19
    v_and_b32 v19, s42, v19
    v_pk_add_f32 v[12:13], v[12:13], s[30:31] op_sel_hi:[1,0] neg_lo:[0,1] neg_hi:[0,1]
    v_pk_add_f32 v[14:15], v[14:15], s[30:31] op_sel_hi:[1,0] neg_lo:[0,1] neg_hi:[0,1]
    v_pk_add_f32 v[16:17], v[16:17], s[30:31] op_sel_hi:[1,0] neg_lo:[0,1] neg_hi:[0,1]
    v_pk_add_f32 v[18:19], v[18:19], s[30:31] op_sel_hi:[1,0] neg_lo:[0,1] neg_hi:[0,1]
    v_pk_add_f32 v[8:9], v[8:9], v[12:13]
    v_pk_fma_f32 v[10:11], v[12:13], v[12:13], v[10:11]
    v_pk_add_f32 v[8:9], v[8:9], v[14:15]
    v_pk_fma_f32 v[10:11], v[14:15], v[14:15], v[10:11]
    v_pk_add_f32 v[8:9], v[8:9], v[16:17]
    v_pk_fma_f32 v[10:11], v[16:17], v[16:17], v[10:11]
    v_pk_add_f32 v[8:9], v[8:9], v[18:19]
    v_pk_fma_f32 v[10:11], v[18:19], v[18:19], v[10:11]
    buffer_load_dwordx4 v[24:27], v0, s[4:7], s27 offen offset:1024 nt
    s_waitcnt vmcnt(14)
    ds_read_b128 v[16:19], v2 offset:8192
    s_waitcnt lgkmcnt(0)
    v_lshlrev_b32 v12, 16, v16
    v_and_b32 v13, s42, v16
    v_lshlrev_b32 v14, 16, v17
    v_and_b32 v15, s42, v17
    v_lshlrev_b32 v16, 16, v18
    v_and_b32 v17, s42, v18
    v_lshlrev_b32 v18, 16, v19
    v_and_b32 v19, s42, v19
    v_pk_add_f32 v[12:13], v[12:13], s[30:31] op_sel_hi:[1,0] neg_lo:[0,1] neg_hi:[0,1]
    v_pk_add_f32 v[14:15], v[14:15], s[30:31] op_sel_hi:[1,0] neg_lo:[0,1] neg_hi:[0,1]
    v_pk_add_f32 v[16:17], v[16:17], s[30:31] op_sel_hi:[1,0] neg_lo:[0,1] neg_hi:[0,1]
    v_pk_add_f32 v[18:19], v[18:19], s[30:31] op_sel_hi:[1,0] neg_lo:[0,1] neg_hi:[0,1]
    v_pk_add_f32 v[8:9], v[8:9], v[12:13]
    v_pk_fma_f32 v[10:11], v[12:13], v[12:13], v[10:11]
    v_pk_add_f32 v[8:9], v[8:9], v[14:15]
    v_pk_fma_f32 v[10:11], v[14:15], v[14:15], v[10:11]
    v_pk_add_f32 v[8:9], v[8:9], v[16:17]
    v_pk_fma_f32 v[10:11], v[16:17], v[16:17], v[10:11]
    v_pk_add_f32 v[8:9], v[8:9], v[18:19]
    v_pk_fma_f32 v[10:11], v[18:19], v[18:19], v[10:11]
    s_add_u32 s27, s27, 131072
    buffer_load_dwordx4 v[28:31], v0, s[4:7], s27 offen nt
    s_waitcnt vmcnt(14)
    ds_read_b128 v[16:19], v2 offset:9216
    s_waitcnt lgkmcnt(0)
    v_lshlrev_b32 v12, 16, v16
    v_and_b32 v13, s42, v16
    v_lshlrev_b32 v14, 16, v17
    v_and_b32 v15, s42, v17
    v_lshlrev_b32 v16, 16, v18
    v_and_b32 v17, s42, v18
    v_lshlrev_b32 v18, 16, v19
    v_and_b32 v19, s42, v19
    v_pk_add_f32 v[12:13], v[12:13], s[30:31] op_sel_hi:[1,0] neg_lo:[0,1] neg_hi:[0,1]
    v_pk_add_f32 v[14:15], v[14:15], s[30:31] op_sel_hi:[1,0] neg_lo:[0,1] neg_hi:[0,1]
    v_pk_add_f32 v[16:17], v[16:17], s[30:31] op_sel_hi:[1,0] neg_lo:[0,1] neg_hi:[0,1]
    v_pk_add_f32 v[18:19], v[18:19], s[30:31] op_sel_hi:[1,0] neg_lo:[0,1] neg_hi:[0,1]
    v_pk_add_f32 v[8:9], v[8:9], v[12:13]
    v_pk_fma_f32 v[10:11], v[12:13], v[12:13], v[10:11]
    v_pk_add_f32 v[8:9], v[8:9], v[14:15]
    v_pk_fma_f32 v[10:11], v[14:15], v[14:15], v[10:11]
    v_pk_add_f32 v[8:9], v[8:9], v[16:17]
    v_pk_fma_f32 v[10:11], v[16:17], v[16:17], v[10:11]
    v_pk_add_f32 v[8:9], v[8:9], v[18:19]
    v_pk_fma_f32 v[10:11], v[18:19], v[18:19], v[10:11]
    buffer_load_dwordx4 v[32:35], v0, s[4:7], s27 offen offset:1024 nt
    s_waitcnt vmcnt(14)
    ds_read_b128 v[16:19], v2 offset:10240
    s_waitcnt lgkmcnt(0)
    v_lshlrev_b32 v12, 16, v16
    v_and_b32 v13, s42, v16
    v_lshlrev_b32 v14, 16, v17
    v_and_b32 v15, s42, v17
    v_lshlrev_b32 v16, 16, v18
    v_and_b32 v17, s42, v18
    v_lshlrev_b32 v18, 16, v19
    v_and_b32 v19, s42, v19
    v_pk_add_f32 v[12:13], v[12:13], s[30:31] op_sel_hi:[1,0] neg_lo:[0,1] neg_hi:[0,1]
    v_pk_add_f32 v[14:15], v[14:15], s[30:31] op_sel_hi:[1,0] neg_lo:[0,1] neg_hi:[0,1]
    v_pk_add_f32 v[16:17], v[16:17], s[30:31] op_sel_hi:[1,0] neg_lo:[0,1] neg_hi:[0,1]
    v_pk_add_f32 v[18:19], v[18:19], s[30:31] op_sel_hi:[1,0] neg_lo:[0,1] neg_hi:[0,1]
    v_pk_add_f32 v[8:9], v[8:9], v[12:13]
    v_pk_fma_f32 v[10:11], v[12:13], v[12:13], v[10:11]
    v_pk_add_f32 v[8:9], v[8:9], v[14:15]
    v_pk_fma_f32 v[10:11], v[14:15], v[14:15], v[10:11]
    v_pk_add_f32 v[8:9], v[8:9], v[16:17]
    v_pk_fma_f32 v[10:11], v[16:17], v[16:17], v[10:11]
    v_pk_add_f32 v[8:9], v[8:9], v[18:19]
    v_pk_fma_f32 v[10:11], v[18:19], v[18:19], v[10:11]
    s_add_u32 s27, s27, 131072
    buffer_load_dwordx4 v[36:39], v0, s[4:7], s27 offen nt
    s_waitcnt vmcnt(14)
    ds_read_b128 v[16:19], v2 offset:11264
    s_waitcnt lgkmcnt(0)
    v_lshlrev_b32 v12, 16, v16
    v_and_b32 v13, s42, v16
    v_lshlrev_b32 v14, 16, v17
    v_and_b32 v15, s42, v17
    v_lshlrev_b32 v16, 16, v18
    v_and_b32 v17, s42, v18
    v_lshlrev_b32 v18, 16, v19
    v_and_b32 v19, s42, v19
    v_pk_add_f32 v[12:13], v[12:13], s[30:31] op_sel_hi:[1,0] neg_lo:[0,1] neg_hi:[0,1]
    v_pk_add_f32 v[14:15], v[14:15], s[30:31] op_sel_hi:[1,0] neg_lo:[0,1] neg_hi:[0,1]
    v_pk_add_f32 v[16:17], v[16:17], s[30:31] op_sel_hi:[1,0] neg_lo:[0,1] neg_hi:[0,1]
    v_pk_add_f32 v[18:19], v[18:19], s[30:31] op_sel_hi:[1,0] neg_lo:[0,1] neg_hi:[0,1]
    v_pk_add_f32 v[8:9], v[8:9], v[12:13]
    v_pk_fma_f32 v[10:11], v[12:13], v[12:13], v[10:11]
    v_pk_add_f32 v[8:9], v[8:9], v[14:15]
    v_pk_fma_f32 v[10:11], v[14:15], v[14:15], v[10:11]
    v_pk_add_f32 v[8:9], v[8:9], v[16:17]
    v_pk_fma_f32 v[10:11], v[16:17], v[16:17], v[10:11]
    v_pk_add_f32 v[8:9], v[8:9], v[18:19]
    v_pk_fma_f32 v[10:11], v[18:19], v[18:19], v[10:11]
    buffer_load_dwordx4 v[40:43], v0, s[4:7], s27 offen offset:1024 nt
    s_waitcnt vmcnt(14)
    ds_read_b128 v[16:19], v2 offset:12288
    s_waitcnt lgkmcnt(0)
    v_lshlrev_b32 v12, 16, v16
    v_and_b32 v13, s42, v16
    v_lshlrev_b32 v14, 16, v17
    v_and_b32 v15, s42, v17
    v_lshlrev_b32 v16, 16, v18
    v_and_b32 v17, s42, v18
    v_lshlrev_b32 v18, 16, v19
    v_and_b32 v19, s42, v19
    v_pk_add_f32 v[12:13], v[12:13], s[30:31] op_sel_hi:[1,0] neg_lo:[0,1] neg_hi:[0,1]
    v_pk_add_f32 v[14:15], v[14:15], s[30:31] op_sel_hi:[1,0] neg_lo:[0,1] neg_hi:[0,1]
    v_pk_add_f32 v[16:17], v[16:17], s[30:31] op_sel_hi:[1,0] neg_lo:[0,1] neg_hi:[0,1]
    v_pk_add_f32 v[18:19], v[18:19], s[30:31] op_sel_hi:[1,0] neg_lo:[0,1] neg_hi:[0,1]
    v_pk_add_f32 v[8:9], v[8:9], v[12:13]
    v_pk_fma_f32 v[10:11], v[12:13], v[12:13], v[10:11]
    v_pk_add_f32 v[8:9], v[8:9], v[14:15]
    v_pk_fma_f32 v[10:11], v[14:15], v[14:15], v[10:11]
    v_pk_add_f32 v[8:9], v[8:9], v[16:17]
    v_pk_fma_f32 v[10:11], v[16:17], v[16:17], v[10:11]
    v_pk_add_f32 v[8:9], v[8:9], v[18:19]
    v_pk_fma_f32 v[10:11], v[18:19], v[18:19], v[10:11]
    s_add_u32 s27, s27, 131072
    buffer_load_dwordx4 v[44:47], v0, s[4:7], s27 offen nt
    s_waitcnt vmcnt(14)
    ds_read_b128 v[16:19], v2 offset:13312
    s_waitcnt lgkmcnt(0)
    v_lshlrev_b32 v12, 16, v16
    v_and_b32 v13, s42, v16
    v_lshlrev_b32 v14, 16, v17
    v_and_b32 v15, s42, v17
    v_lshlrev_b32 v16, 16, v18
    v_and_b32 v17, s42, v18
    v_lshlrev_b32 v18, 16, v19
    v_and_b32 v19, s42, v19
    v_pk_add_f32 v[12:13], v[12:13], s[30:31] op_sel_hi:[1,0] neg_lo:[0,1] neg_hi:[0,1]
    v_pk_add_f32 v[14:15], v[14:15], s[30:31] op_sel_hi:[1,0] neg_lo:[0,1] neg_hi:[0,1]
    v_pk_add_f32 v[16:17], v[16:17], s[30:31] op_sel_hi:[1,0] neg_lo:[0,1] neg_hi:[0,1]
    v_pk_add_f32 v[18:19], v[18:19], s[30:31] op_sel_hi:[1,0] neg_lo:[0,1] neg_hi:[0,1]
    v_pk_add_f32 v[8:9], v[8:9], v[12:13]
    v_pk_fma_f32 v[10:11], v[12:13], v[12:13], v[10:11]
    v_pk_add_f32 v[8:9], v[8:9], v[14:15]
    v_pk_fma_f32 v[10:11], v[14:15], v[14:15], v[10:11]
    v_pk_add_f32 v[8:9], v[8:9], v[16:17]
    v_pk_fma_f32 v[10:11], v[16:17], v[16:17], v[10:11]
    v_pk_add_f32 v[8:9], v[8:9], v[18:19]
    v_pk_fma_f32 v[10:11], v[18:19], v[18:19], v[10:11]
    buffer_load_dwordx4 v[48:51], v0, s[4:7], s27 offen offset:1024 nt
    s_waitcnt vmcnt(14)
    ds_read_b128 v[16:19], v2 offset:14336
    s_waitcnt lgkmcnt(0)
    v_lshlrev_b32 v12, 16, v16
    v_and_b32 v13, s42, v16
    v_lshlrev_b32 v14, 16, v17
    v_and_b32 v15, s42, v17
    v_lshlrev_b32 v16, 16, v18
    v_and_b32 v17, s42, v18
    v_lshlrev_b32 v18, 16, v19
    v_and_b32 v19, s42, v19
    v_pk_add_f32 v[12:13], v[12:13], s[30:31] op_sel_hi:[1,0] neg_lo:[0,1] neg_hi:[0,1]
    v_pk_add_f32 v[14:15], v[14:15], s[30:31] op_sel_hi:[1,0] neg_lo:[0,1] neg_hi:[0,1]
    v_pk_add_f32 v[16:17], v[16:17], s[30:31] op_sel_hi:[1,0] neg_lo:[0,1] neg_hi:[0,1]
    v_pk_add_f32 v[18:19], v[18:19], s[30:31] op_sel_hi:[1,0] neg_lo:[0,1] neg_hi:[0,1]
    v_pk_add_f32 v[8:9], v[8:9], v[12:13]
    v_pk_fma_f32 v[10:11], v[12:13], v[12:13], v[10:11]
    v_pk_add_f32 v[8:9], v[8:9], v[14:15]
    v_pk_fma_f32 v[10:11], v[14:15], v[14:15], v[10:11]
    v_pk_add_f32 v[8:9], v[8:9], v[16:17]
    v_pk_fma_f32 v[10:11], v[16:17], v[16:17], v[10:11]
    v_pk_add_f32 v[8:9], v[8:9], v[18:19]
    v_pk_fma_f32 v[10:11], v[18:19], v[18:19], v[10:11]
    s_add_u32 s27, s27, 131072
    buffer_load_dwordx4 v[52:55], v0, s[4:7], s27 offen nt
    s_waitcnt vmcnt(14)
    ds_read_b128 v[16:19], v2 offset:15360
    s_waitcnt lgkmcnt(0)
    v_lshlrev_b32 v12, 16, v16
    v_and_b32 v13, s42, v16
    v_lshlrev_b32 v14, 16, v17
    v_and_b32 v15, s42, v17
    v_lshlrev_b32 v16, 16, v18
    v_and_b32 v17, s42, v18
    v_lshlrev_b32 v18, 16, v19
    v_and_b32 v19, s42, v19
    v_pk_add_f32 v[12:13], v[12:13], s[30:31] op_sel_hi:[1,0] neg_lo:[0,1] neg_hi:[0,1]
    v_pk_add_f32 v[14:15], v[14:15], s[30:31] op_sel_hi:[1,0] neg_lo:[0,1] neg_hi:[0,1]
    v_pk_add_f32 v[16:17], v[16:17], s[30:31] op_sel_hi:[1,0] neg_lo:[0,1] neg_hi:[0,1]
    v_pk_add_f32 v[18:19], v[18:19], s[30:31] op_sel_hi:[1,0] neg_lo:[0,1] neg_hi:[0,1]
    v_pk_add_f32 v[8:9], v[8:9], v[12:13]
    v_pk_fma_f32 v[10:11], v[12:13], v[12:13], v[10:11]
    v_pk_add_f32 v[8:9], v[8:9], v[14:15]
    v_pk_fma_f32 v[10:11], v[14:15], v[14:15], v[10:11]
    v_pk_add_f32 v[8:9], v[8:9], v[16:17]
    v_pk_fma_f32 v[10:11], v[16:17], v[16:17], v[10:11]
    v_pk_add_f32 v[8:9], v[8:9], v[18:19]
    v_pk_fma_f32 v[10:11], v[18:19], v[18:19], v[10:11]
    buffer_load_dwordx4 v[56:59], v0, s[4:7], s27 offen offset:1024 nt
    s_waitcnt vmcnt(14)
    ds_read_b128 v[16:19], v2 offset:16384
    s_waitcnt lgkmcnt(0)
    v_lshlrev_b32 v12, 16, v16
    v_and_b32 v13, s42, v16
    v_lshlrev_b32 v14, 16, v17
    v_and_b32 v15, s42, v17
    v_lshlrev_b32 v16, 16, v18
    v_and_b32 v17, s42, v18
    v_lshlrev_b32 v18, 16, v19
    v_and_b32 v19, s42, v19
    v_pk_add_f32 v[12:13], v[12:13], s[30:31] op_sel_hi:[1,0] neg_lo:[0,1] neg_hi:[0,1]
    v_pk_add_f32 v[14:15], v[14:15], s[30:31] op_sel_hi:[1,0] neg_lo:[0,1] neg_hi:[0,1]
    v_pk_add_f32 v[16:17], v[16:17], s[30:31] op_sel_hi:[1,0] neg_lo:[0,1] neg_hi:[0,1]
    v_pk_add_f32 v[18:19], v[18:19], s[30:31] op_sel_hi:[1,0] neg_lo:[0,1] neg_hi:[0,1]
    v_pk_add_f32 v[8:9], v[8:9], v[12:13]
    v_pk_fma_f32 v[10:11], v[12:13], v[12:13], v[10:11]
    v_pk_add_f32 v[8:9], v[8:9], v[14:15]
    v_pk_fma_f32 v[10:11], v[14:15], v[14:15], v[10:11]
    v_pk_add_f32 v[8:9], v[8:9], v[16:17]
    v_pk_fma_f32 v[10:11], v[16:17], v[16:17], v[10:11]
    v_pk_add_f32 v[8:9], v[8:9], v[18:19]
    v_pk_fma_f32 v[10:11], v[18:19], v[18:19], v[10:11]
    s_add_u32 s27, s27, 131072
    buffer_load_dwordx4 v[60:63], v0, s[4:7], s27 offen nt
    s_waitcnt vmcnt(14)
    ds_read_b128 v[16:19], v2 offset:17408
    s_waitcnt lgkmcnt(0)
    v_lshlrev_b32 v12, 16, v16
    v_and_b32 v13, s42, v16
    v_lshlrev_b32 v14, 16, v17
    v_and_b32 v15, s42, v17
    v_lshlrev_b32 v16, 16, v18
    v_and_b32 v17, s42, v18
    v_lshlrev_b32 v18, 16, v19
    v_and_b32 v19, s42, v19
    v_pk_add_f32 v[12:13], v[12:13], s[30:31] op_sel_hi:[1,0] neg_lo:[0,1] neg_hi:[0,1]
    v_pk_add_f32 v[14:15], v[14:15], s[30:31] op_sel_hi:[1,0] neg_lo:[0,1] neg_hi:[0,1]
    v_pk_add_f32 v[16:17], v[16:17], s[30:31] op_sel_hi:[1,0] neg_lo:[0,1] neg_hi:[0,1]
    v_pk_add_f32 v[18:19], v[18:19], s[30:31] op_sel_hi:[1,0] neg_lo:[0,1] neg_hi:[0,1]
    v_pk_add_f32 v[8:9], v[8:9], v[12:13]
    v_pk_fma_f32 v[10:11], v[12:13], v[12:13], v[10:11]
    v_pk_add_f32 v[8:9], v[8:9], v[14:15]
    v_pk_fma_f32 v[10:11], v[14:15], v[14:15], v[10:11]
    v_pk_add_f32 v[8:9], v[8:9], v[16:17]
    v_pk_fma_f32 v[10:11], v[16:17], v[16:17], v[10:11]
    v_pk_add_f32 v[8:9], v[8:9], v[18:19]
    v_pk_fma_f32 v[10:11], v[18:19], v[18:19], v[10:11]
    buffer_load_dwordx4 v[64:67], v0, s[4:7], s27 offen offset:1024 nt
    s_waitcnt vmcnt(11)
    v_lshlrev_b32 v12, 16, v20
    v_and_b32 v13, s42, v20
    v_lshlrev_b32 v14, 16, v21
    v_and_b32 v15, s42, v21
    v_lshlrev_b32 v16, 16, v22
    v_and_b32 v17, s42, v22
    v_lshlrev_b32 v18, 16, v23
    v_and_b32 v19, s42, v23
    v_pk_add_f32 v[12:13], v[12:13], s[30:31] op_sel_hi:[1,0] neg_lo:[0,1] neg_hi:[0,1]
    v_pk_add_f32 v[14:15], v[14:15], s[30:31] op_sel_hi:[1,0] neg_lo:[0,1] neg_hi:[0,1]
    v_pk_add_f32 v[16:17], v[16:17], s[30:31] op_sel_hi:[1,0] neg_lo:[0,1] neg_hi:[0,1]
    v_pk_add_f32 v[18:19], v[18:19], s[30:31] op_sel_hi:[1,0] neg_lo:[0,1] neg_hi:[0,1]
    v_pk_add_f32 v[8:9], v[8:9], v[12:13]
    v_pk_fma_f32 v[10:11], v[12:13], v[12:13], v[10:11]
    v_pk_add_f32 v[8:9], v[8:9], v[14:15]
    v_pk_fma_f32 v[10:11], v[14:15], v[14:15], v[10:11]
    v_pk_add_f32 v[8:9], v[8:9], v[16:17]
    v_pk_fma_f32 v[10:11], v[16:17], v[16:17], v[10:11]
    v_pk_add_f32 v[8:9], v[8:9], v[18:19]
    v_pk_fma_f32 v[10:11], v[18:19], v[18:19], v[10:11]
    s_add_u32 s27, s27, 131072
    buffer_load_dwordx4 v[68:71], v0, s[4:7], s27 offen nt
    s_waitcnt vmcnt(11)
    v_lshlrev_b32 v12, 16, v24
    v_and_b32 v13, s42, v24
    v_lshlrev_b32 v14, 16, v25
    v_and_b32 v15, s42, v25
    v_lshlrev_b32 v16, 16, v26
    v_and_b32 v17, s42, v26
    v_lshlrev_b32 v18, 16, v27
    v_and_b32 v19, s42, v27
    v_pk_add_f32 v[12:13], v[12:13], s[30:31] op_sel_hi:[1,0] neg_lo:[0,1] neg_hi:[0,1]
    v_pk_add_f32 v[14:15], v[14:15], s[30:31] op_sel_hi:[1,0] neg_lo:[0,1] neg_hi:[0,1]
    v_pk_add_f32 v[16:17], v[16:17], s[30:31] op_sel_hi:[1,0] neg_lo:[0,1] neg_hi:[0,1]
    v_pk_add_f32 v[18:19], v[18:19], s[30:31] op_sel_hi:[1,0] neg_lo:[0,1] neg_hi:[0,1]
    v_pk_add_f32 v[8:9], v[8:9], v[12:13]
    v_pk_fma_f32 v[10:11], v[12:13], v[12:13], v[10:11]
    v_pk_add_f32 v[8:9], v[8:9], v[14:15]
    v_pk_fma_f32 v[10:11], v[14:15], v[14:15], v[10:11]
    v_pk_add_f32 v[8:9], v[8:9], v[16:17]
    v_pk_fma_f32 v[10:11], v[16:17], v[16:17], v[10:11]
    v_pk_add_f32 v[8:9], v[8:9], v[18:19]
    v_pk_fma_f32 v[10:11], v[18:19], v[18:19], v[10:11]
    buffer_load_dwordx4 v[72:75], v0, s[4:7], s27 offen offset:1024 nt
    v_lshl_or_b32 v3, v5, 16, v3
    s_waitcnt vmcnt(11)
    v_lshlrev_b32 v12, 16, v28
    v_and_b32 v13, s42, v28
    v_lshlrev_b32 v14, 16, v29
    v_and_b32 v15, s42, v29
    v_lshlrev_b32 v16, 16, v30
    v_and_b32 v17, s42, v30
    v_lshlrev_b32 v18, 16, v31
    v_and_b32 v19, s42, v31
    v_pk_add_f32 v[12:13], v[12:13], s[30:31] op_sel_hi:[1,0] neg_lo:[0,1] neg_hi:[0,1]
    v_pk_add_f32 v[14:15], v[14:15], s[30:31] op_sel_hi:[1,0] neg_lo:[0,1] neg_hi:[0,1]
    v_pk_add_f32 v[16:17], v[16:17], s[30:31] op_sel_hi:[1,0] neg_lo:[0,1] neg_hi:[0,1]
    v_pk_add_f32 v[18:19], v[18:19], s[30:31] op_sel_hi:[1,0] neg_lo:[0,1] neg_hi:[0,1]
    v_pk_add_f32 v[8:9], v[8:9], v[12:13]
    v_pk_fma_f32 v[10:11], v[12:13], v[12:13], v[10:11]
    v_pk_add_f32 v[8:9], v[8:9], v[14:15]
    v_pk_fma_f32 v[10:11], v[14:15], v[14:15], v[10:11]
    v_pk_add_f32 v[8:9], v[8:9], v[16:17]
    v_pk_fma_f32 v[10:11], v[16:17], v[16:17], v[10:11]
    v_pk_add_f32 v[8:9], v[8:9], v[18:19]
    v_pk_fma_f32 v[10:11], v[18:19], v[18:19], v[10:11]
    s_add_u32 s27, s27, 131072
    buffer_load_dwordx4 v[76:79], v0, s[4:7], s27 offen nt
    s_waitcnt vmcnt(11)
    v_lshlrev_b32 v12, 16, v32
    v_and_b32 v13, s42, v32
    v_lshlrev_b32 v14, 16, v33
    v_and_b32 v15, s42, v33
    v_lshlrev_b32 v16, 16, v34
    v_and_b32 v17, s42, v34
    v_lshlrev_b32 v18, 16, v35
    v_and_b32 v19, s42, v35
    v_pk_add_f32 v[12:13], v[12:13], s[30:31] op_sel_hi:[1,0] neg_lo:[0,1] neg_hi:[0,1]
    v_pk_add_f32 v[14:15], v[14:15], s[30:31] op_sel_hi:[1,0] neg_lo:[0,1] neg_hi:[0,1]
    v_pk_add_f32 v[16:17], v[16:17], s[30:31] op_sel_hi:[1,0] neg_lo:[0,1] neg_hi:[0,1]
    v_pk_add_f32 v[18:19], v[18:19], s[30:31] op_sel_hi:[1,0] neg_lo:[0,1] neg_hi:[0,1]
    v_pk_add_f32 v[8:9], v[8:9], v[12:13]
    v_pk_fma_f32 v[10:11], v[12:13], v[12:13], v[10:11]
    v_pk_add_f32 v[8:9], v[8:9], v[14:15]
    v_pk_fma_f32 v[10:11], v[14:15], v[14:15], v[10:11]
    v_pk_add_f32 v[8:9], v[8:9], v[16:17]
    v_pk_fma_f32 v[10:11], v[16:17], v[16:17], v[10:11]
    v_pk_add_f32 v[8:9], v[8:9], v[18:19]
    v_pk_fma_f32 v[10:11], v[18:19], v[18:19], v[10:11]
    buffer_load_dwordx4 v[80:83], v0, s[4:7], s27 offen offset:1024 nt
    s_waitcnt vmcnt(11)
    v_lshlrev_b32 v12, 16, v36
    v_and_b32 v13, s42, v36
    v_lshlrev_b32 v14, 16, v37
    v_and_b32 v15, s42, v37
    v_lshlrev_b32 v16, 16, v38
    v_and_b32 v17, s42, v38
    v_lshlrev_b32 v18, 16, v39
    v_and_b32 v19, s42, v39
    v_pk_add_f32 v[12:13], v[12:13], s[30:31] op_sel_hi:[1,0] neg_lo:[0,1] neg_hi:[0,1]
    v_pk_add_f32 v[14:15], v[14:15], s[30:31] op_sel_hi:[1,0] neg_lo:[0,1] neg_hi:[0,1]
    v_pk_add_f32 v[16:17], v[16:17], s[30:31] op_sel_hi:[1,0] neg_lo:[0,1] neg_hi:[0,1]
    v_pk_add_f32 v[18:19], v[18:19], s[30:31] op_sel_hi:[1,0] neg_lo:[0,1] neg_hi:[0,1]
    v_pk_add_f32 v[8:9], v[8:9], v[12:13]
    v_pk_fma_f32 v[10:11], v[12:13], v[12:13], v[10:11]
    v_pk_add_f32 v[8:9], v[8:9], v[14:15]
    v_pk_fma_f32 v[10:11], v[14:15], v[14:15], v[10:11]
    v_pk_add_f32 v[8:9], v[8:9], v[16:17]
    v_pk_fma_f32 v[10:11], v[16:17], v[16:17], v[10:11]
    v_pk_add_f32 v[8:9], v[8:9], v[18:19]
    v_pk_fma_f32 v[10:11], v[18:19], v[18:19], v[10:11]
    s_add_u32 s27, s27, 131072
    buffer_load_dwordx4 v[84:87], v0, s[4:7], s27 offen nt
    s_waitcnt vmcnt(11)
    v_lshlrev_b32 v12, 16, v40
    v_and_b32 v13, s42, v40
    v_lshlrev_b32 v14, 16, v41
    v_and_b32 v15, s42, v41
    v_lshlrev_b32 v16, 16, v42
    v_and_b32 v17, s42, v42
    v_lshlrev_b32 v18, 16, v43
    v_and_b32 v19, s42, v43
    v_pk_add_f32 v[12:13], v[12:13], s[30:31] op_sel_hi:[1,0] neg_lo:[0,1] neg_hi:[0,1]
    v_pk_add_f32 v[14:15], v[14:15], s[30:31] op_sel_hi:[1,0] neg_lo:[0,1] neg_hi:[0,1]
    v_pk_add_f32 v[16:17], v[16:17], s[30:31] op_sel_hi:[1,0] neg_lo:[0,1] neg_hi:[0,1]
    v_pk_add_f32 v[18:19], v[18:19], s[30:31] op_sel_hi:[1,0] neg_lo:[0,1] neg_hi:[0,1]
    v_pk_add_f32 v[8:9], v[8:9], v[12:13]
    v_pk_fma_f32 v[10:11], v[12:13], v[12:13], v[10:11]
    v_pk_add_f32 v[8:9], v[8:9], v[14:15]
    v_pk_fma_f32 v[10:11], v[14:15], v[14:15], v[10:11]
    v_pk_add_f32 v[8:9], v[8:9], v[16:17]
    v_pk_fma_f32 v[10:11], v[16:17], v[16:17], v[10:11]
    v_pk_add_f32 v[8:9], v[8:9], v[18:19]
    v_pk_fma_f32 v[10:11], v[18:19], v[18:19], v[10:11]
    buffer_load_dwordx4 v[88:91], v0, s[4:7], s27 offen offset:1024 nt
    s_waitcnt vmcnt(11)
    v_lshlrev_b32 v12, 16, v44
    v_and_b32 v13, s42, v44
    v_lshlrev_b32 v14, 16, v45
    v_and_b32 v15, s42, v45
    v_lshlrev_b32 v16, 16, v46
    v_and_b32 v17, s42, v46
    v_lshlrev_b32 v18, 16, v47
    v_and_b32 v19, s42, v47
    v_pk_add_f32 v[12:13], v[12:13], s[30:31] op_sel_hi:[1,0] neg_lo:[0,1] neg_hi:[0,1]
    v_pk_add_f32 v[14:15], v[14:15], s[30:31] op_sel_hi:[1,0] neg_lo:[0,1] neg_hi:[0,1]
    v_pk_add_f32 v[16:17], v[16:17], s[30:31] op_sel_hi:[1,0] neg_lo:[0,1] neg_hi:[0,1]
    v_pk_add_f32 v[18:19], v[18:19], s[30:31] op_sel_hi:[1,0] neg_lo:[0,1] neg_hi:[0,1]
    v_pk_add_f32 v[8:9], v[8:9], v[12:13]
    v_pk_fma_f32 v[10:11], v[12:13], v[12:13], v[10:11]
    v_pk_add_f32 v[8:9], v[8:9], v[14:15]
    v_pk_fma_f32 v[10:11], v[14:15], v[14:15], v[10:11]
    v_pk_add_f32 v[8:9], v[8:9], v[16:17]
    v_pk_fma_f32 v[10:11], v[16:17], v[16:17], v[10:11]
    v_pk_add_f32 v[8:9], v[8:9], v[18:19]
    v_pk_fma_f32 v[10:11], v[18:19], v[18:19], v[10:11]
    s_mov_b32 s27, s29
    buffer_load_dwordx4 v[92:95], v0, s[4:7], s27 offen nt
    s_waitcnt vmcnt(11)
    v_lshlrev_b32 v12, 16, v48
    v_and_b32 v13, s42, v48
    v_lshlrev_b32 v14, 16, v49
    v_and_b32 v15, s42, v49
    v_lshlrev_b32 v16, 16, v50
    v_and_b32 v17, s42, v50
    v_lshlrev_b32 v18, 16, v51
    v_and_b32 v19, s42, v51
    v_pk_add_f32 v[12:13], v[12:13], s[30:31] op_sel_hi:[1,0] neg_lo:[0,1] neg_hi:[0,1]
    v_pk_add_f32 v[14:15], v[14:15], s[30:31] op_sel_hi:[1,0] neg_lo:[0,1] neg_hi:[0,1]
    v_pk_add_f32 v[16:17], v[16:17], s[30:31] op_sel_hi:[1,0] neg_lo:[0,1] neg_hi:[0,1]
    v_pk_add_f32 v[18:19], v[18:19], s[30:31] op_sel_hi:[1,0] neg_lo:[0,1] neg_hi:[0,1]
    v_pk_add_f32 v[8:9], v[8:9], v[12:13]
    v_pk_fma_f32 v[10:11], v[12:13], v[12:13], v[10:11]
    v_pk_add_f32 v[8:9], v[8:9], v[14:15]
    v_pk_fma_f32 v[10:11], v[14:15], v[14:15], v[10:11]
    v_pk_add_f32 v[8:9], v[8:9], v[16:17]
    v_pk_fma_f32 v[10:11], v[16:17], v[16:17], v[10:11]
    v_pk_add_f32 v[8:9], v[8:9], v[18:19]
    v_pk_fma_f32 v[10:11], v[18:19], v[18:19], v[10:11]
    buffer_load_dwordx4 v[96:99], v0, s[4:7], s27 offen offset:1024 nt
    s_waitcnt vmcnt(11)
    v_lshlrev_b32 v12, 16, v52
    v_and_b32 v13, s42, v52
    v_lshlrev_b32 v14, 16, v53
    v_and_b32 v15, s42, v53
    v_lshlrev_b32 v16, 16, v54
    v_and_b32 v17, s42, v54
    v_lshlrev_b32 v18, 16, v55
    v_and_b32 v19, s42, v55
    v_pk_add_f32 v[12:13], v[12:13], s[30:31] op_sel_hi:[1,0] neg_lo:[0,1] neg_hi:[0,1]
    v_pk_add_f32 v[14:15], v[14:15], s[30:31] op_sel_hi:[1,0] neg_lo:[0,1] neg_hi:[0,1]
    v_pk_add_f32 v[16:17], v[16:17], s[30:31] op_sel_hi:[1,0] neg_lo:[0,1] neg_hi:[0,1]
    v_pk_add_f32 v[18:19], v[18:19], s[30:31] op_sel_hi:[1,0] neg_lo:[0,1] neg_hi:[0,1]
    v_pk_add_f32 v[8:9], v[8:9], v[12:13]
    v_pk_fma_f32 v[10:11], v[12:13], v[12:13], v[10:11]
    v_pk_add_f32 v[8:9], v[8:9], v[14:15]
    v_pk_fma_f32 v[10:11], v[14:15], v[14:15], v[10:11]
    v_pk_add_f32 v[8:9], v[8:9], v[16:17]
    v_pk_fma_f32 v[10:11], v[16:17], v[16:17], v[10:11]
    v_pk_add_f32 v[8:9], v[8:9], v[18:19]
    v_pk_fma_f32 v[10:11], v[18:19], v[18:19], v[10:11]
    s_add_u32 s27, s27, 131072
    buffer_load_dwordx4 v[100:103], v0, s[4:7], s27 offen nt
    s_waitcnt vmcnt(11)
    v_lshlrev_b32 v12, 16, v56
    v_and_b32 v13, s42, v56
    v_lshlrev_b32 v14, 16, v57
    v_and_b32 v15, s42, v57
    v_lshlrev_b32 v16, 16, v58
    v_and_b32 v17, s42, v58
    v_lshlrev_b32 v18, 16, v59
    v_and_b32 v19, s42, v59
    v_pk_add_f32 v[12:13], v[12:13], s[30:31] op_sel_hi:[1,0] neg_lo:[0,1] neg_hi:[0,1]
    v_pk_add_f32 v[14:15], v[14:15], s[30:31] op_sel_hi:[1,0] neg_lo:[0,1] neg_hi:[0,1]
    v_pk_add_f32 v[16:17], v[16:17], s[30:31] op_sel_hi:[1,0] neg_lo:[0,1] neg_hi:[0,1]
    v_pk_add_f32 v[18:19], v[18:19], s[30:31] op_sel_hi:[1,0] neg_lo:[0,1] neg_hi:[0,1]
    v_pk_add_f32 v[8:9], v[8:9], v[12:13]
    v_pk_fma_f32 v[10:11], v[12:13], v[12:13], v[10:11]
    v_pk_add_f32 v[8:9], v[8:9], v[14:15]
    v_pk_fma_f32 v[10:11], v[14:15], v[14:15], v[10:11]
    v_pk_add_f32 v[8:9], v[8:9], v[16:17]
    v_pk_fma_f32 v[10:11], v[16:17], v[16:17], v[10:11]
    v_pk_add_f32 v[8:9], v[8:9], v[18:19]
    v_pk_fma_f32 v[10:11], v[18:19], v[18:19], v[10:11]
    buffer_load_dwordx4 v[104:107], v0, s[4:7], s27 offen offset:1024 nt
    s_waitcnt vmcnt(11)
    v_lshlrev_b32 v12, 16, v60
    v_and_b32 v13, s42, v60
    v_lshlrev_b32 v14, 16, v61
    v_and_b32 v15, s42, v61
    v_lshlrev_b32 v16, 16, v62
    v_and_b32 v17, s42, v62
    v_lshlrev_b32 v18, 16, v63
    v_and_b32 v19, s42, v63
    v_pk_add_f32 v[12:13], v[12:13], s[30:31] op_sel_hi:[1,0] neg_lo:[0,1] neg_hi:[0,1]
    v_pk_add_f32 v[14:15], v[14:15], s[30:31] op_sel_hi:[1,0] neg_lo:[0,1] neg_hi:[0,1]
    v_pk_add_f32 v[16:17], v[16:17], s[30:31] op_sel_hi:[1,0] neg_lo:[0,1] neg_hi:[0,1]
    v_pk_add_f32 v[18:19], v[18:19], s[30:31] op_sel_hi:[1,0] neg_lo:[0,1] neg_hi:[0,1]
    v_pk_add_f32 v[8:9], v[8:9], v[12:13]
    v_pk_fma_f32 v[10:11], v[12:13], v[12:13], v[10:11]
    v_pk_add_f32 v[8:9], v[8:9], v[14:15]
    v_pk_fma_f32 v[10:11], v[14:15], v[14:15], v[10:11]
    v_pk_add_f32 v[8:9], v[8:9], v[16:17]
    v_pk_fma_f32 v[10:11], v[16:17], v[16:17], v[10:11]
    v_pk_add_f32 v[8:9], v[8:9], v[18:19]
    v_pk_fma_f32 v[10:11], v[18:19], v[18:19], v[10:11]
    s_add_u32 s27, s27, 131072
    buffer_load_dwordx4 v[108:111], v0, s[4:7], s27 offen nt
    s_waitcnt vmcnt(11)
    v_lshlrev_b32 v12, 16, v64
    v_and_b32 v13, s42, v64
    v_lshlrev_b32 v14, 16, v65
    v_and_b32 v15, s42, v65
    v_lshlrev_b32 v16, 16, v66
    v_and_b32 v17, s42, v66
    v_lshlrev_b32 v18, 16, v67
    v_and_b32 v19, s42, v67
    v_pk_add_f32 v[12:13], v[12:13], s[30:31] op_sel_hi:[1,0] neg_lo:[0,1] neg_hi:[0,1]
    v_pk_add_f32 v[14:15], v[14:15], s[30:31] op_sel_hi:[1,0] neg_lo:[0,1] neg_hi:[0,1]
    v_pk_add_f32 v[16:17], v[16:17], s[30:31] op_sel_hi:[1,0] neg_lo:[0,1] neg_hi:[0,1]
    v_pk_add_f32 v[18:19], v[18:19], s[30:31] op_sel_hi:[1,0] neg_lo:[0,1] neg_hi:[0,1]
    v_pk_add_f32 v[8:9], v[8:9], v[12:13]
    v_pk_fma_f32 v[10:11], v[12:13], v[12:13], v[10:11]
    v_pk_add_f32 v[8:9], v[8:9], v[14:15]
    v_pk_fma_f32 v[10:11], v[14:15], v[14:15], v[10:11]
    v_pk_add_f32 v[8:9], v[8:9], v[16:17]
    v_pk_fma_f32 v[10:11], v[16:17], v[16:17], v[10:11]
    v_pk_add_f32 v[8:9], v[8:9], v[18:19]
    v_pk_fma_f32 v[10:11], v[18:19], v[18:19], v[10:11]
    buffer_load_dwordx4 v[112:115], v0, s[4:7], s27 offen offset:1024 nt
    s_waitcnt vmcnt(11)
    v_lshlrev_b32 v12, 16, v68
    v_and_b32 v13, s42, v68
    v_lshlrev_b32 v14, 16, v69
    v_and_b32 v15, s42, v69
    v_lshlrev_b32 v16, 16, v70
    v_and_b32 v17, s42, v70
    v_lshlrev_b32 v18, 16, v71
    v_and_b32 v19, s42, v71
    v_pk_add_f32 v[12:13], v[12:13], s[30:31] op_sel_hi:[1,0] neg_lo:[0,1] neg_hi:[0,1]
    v_pk_add_f32 v[14:15], v[14:15], s[30:31] op_sel_hi:[1,0] neg_lo:[0,1] neg_hi:[0,1]
    v_pk_add_f32 v[16:17], v[16:17], s[30:31] op_sel_hi:[1,0] neg_lo:[0,1] neg_hi:[0,1]
    v_pk_add_f32 v[18:19], v[18:19], s[30:31] op_sel_hi:[1,0] neg_lo:[0,1] neg_hi:[0,1]
    v_pk_add_f32 v[8:9], v[8:9], v[12:13]
    v_pk_fma_f32 v[10:11], v[12:13], v[12:13], v[10:11]
    v_pk_add_f32 v[8:9], v[8:9], v[14:15]
    v_pk_fma_f32 v[10:11], v[14:15], v[14:15], v[10:11]
    v_pk_add_f32 v[8:9], v[8:9], v[16:17]
    v_pk_fma_f32 v[10:11], v[16:17], v[16:17], v[10:11]
    v_pk_add_f32 v[8:9], v[8:9], v[18:19]
    v_pk_fma_f32 v[10:11], v[18:19], v[18:19], v[10:11]
    s_add_u32 s27, s27, 131072
    buffer_load_dwordx4 v[116:119], v0, s[4:7], s27 offen nt
    s_waitcnt vmcnt(11)
    v_lshlrev_b32 v12, 16, v72
    v_and_b32 v13, s42, v72
    v_lshlrev_b32 v14, 16, v73
    v_and_b32 v15, s42, v73
    v_lshlrev_b32 v16, 16, v74
    v_and_b32 v17, s42, v74
    v_lshlrev_b32 v18, 16, v75
    v_and_b32 v19, s42, v75
    v_pk_add_f32 v[12:13], v[12:13], s[30:31] op_sel_hi:[1,0] neg_lo:[0,1] neg_hi:[0,1]
    v_pk_add_f32 v[14:15], v[14:15], s[30:31] op_sel_hi:[1,0] neg_lo:[0,1] neg_hi:[0,1]
    v_pk_add_f32 v[16:17], v[16:17], s[30:31] op_sel_hi:[1,0] neg_lo:[0,1] neg_hi:[0,1]
    v_pk_add_f32 v[18:19], v[18:19], s[30:31] op_sel_hi:[1,0] neg_lo:[0,1] neg_hi:[0,1]
    v_pk_add_f32 v[8:9], v[8:9], v[12:13]
    v_pk_fma_f32 v[10:11], v[12:13], v[12:13], v[10:11]
    v_pk_add_f32 v[8:9], v[8:9], v[14:15]
    v_pk_fma_f32 v[10:11], v[14:15], v[14:15], v[10:11]
    v_pk_add_f32 v[8:9], v[8:9], v[16:17]
    v_pk_fma_f32 v[10:11], v[16:17], v[16:17], v[10:11]
    v_pk_add_f32 v[8:9], v[8:9], v[18:19]
    v_pk_fma_f32 v[10:11], v[18:19], v[18:19], v[10:11]
    buffer_load_dwordx4 v[120:123], v0, s[4:7], s27 offen offset:1024 nt
    s_waitcnt vmcnt(11)
    v_lshlrev_b32 v12, 16, v76
    v_and_b32 v13, s42, v76
    v_lshlrev_b32 v14, 16, v77
    v_and_b32 v15, s42, v77
    v_lshlrev_b32 v16, 16, v78
    v_and_b32 v17, s42, v78
    v_lshlrev_b32 v18, 16, v79
    v_and_b32 v19, s42, v79
    v_pk_add_f32 v[12:13], v[12:13], s[30:31] op_sel_hi:[1,0] neg_lo:[0,1] neg_hi:[0,1]
    v_pk_add_f32 v[14:15], v[14:15], s[30:31] op_sel_hi:[1,0] neg_lo:[0,1] neg_hi:[0,1]
    v_pk_add_f32 v[16:17], v[16:17], s[30:31] op_sel_hi:[1,0] neg_lo:[0,1] neg_hi:[0,1]
    v_pk_add_f32 v[18:19], v[18:19], s[30:31] op_sel_hi:[1,0] neg_lo:[0,1] neg_hi:[0,1]
    v_pk_add_f32 v[8:9], v[8:9], v[12:13]
    v_pk_fma_f32 v[10:11], v[12:13], v[12:13], v[10:11]
    v_pk_add_f32 v[8:9], v[8:9], v[14:15]
    v_pk_fma_f32 v[10:11], v[14:15], v[14:15], v[10:11]
    v_pk_add_f32 v[8:9], v[8:9], v[16:17]
    v_pk_fma_f32 v[10:11], v[16:17], v[16:17], v[10:11]
    v_pk_add_f32 v[8:9], v[8:9], v[18:19]
    v_pk_fma_f32 v[10:11], v[18:19], v[18:19], v[10:11]
    s_add_u32 s27, s27, 131072
    buffer_load_dwordx4 v[124:127], v0, s[4:7], s27 offen nt
    s_waitcnt vmcnt(11)
    v_lshlrev_b32 v12, 16, v80
    v_and_b32 v13, s42, v80
    v_lshlrev_b32 v14, 16, v81
    v_and_b32 v15, s42, v81
    v_lshlrev_b32 v16, 16, v82
    v_and_b32 v17, s42, v82
    v_lshlrev_b32 v18, 16, v83
    v_and_b32 v19, s42, v83
    v_pk_add_f32 v[12:13], v[12:13], s[30:31] op_sel_hi:[1,0] neg_lo:[0,1] neg_hi:[0,1]
    v_pk_add_f32 v[14:15], v[14:15], s[30:31] op_sel_hi:[1,0] neg_lo:[0,1] neg_hi:[0,1]
    v_pk_add_f32 v[16:17], v[16:17], s[30:31] op_sel_hi:[1,0] neg_lo:[0,1] neg_hi:[0,1]
    v_pk_add_f32 v[18:19], v[18:19], s[30:31] op_sel_hi:[1,0] neg_lo:[0,1] neg_hi:[0,1]
    v_pk_add_f32 v[8:9], v[8:9], v[12:13]
    v_pk_fma_f32 v[10:11], v[12:13], v[12:13], v[10:11]
    v_pk_add_f32 v[8:9], v[8:9], v[14:15]
    v_pk_fma_f32 v[10:11], v[14:15], v[14:15], v[10:11]
    v_pk_add_f32 v[8:9], v[8:9], v[16:17]
    v_pk_fma_f32 v[10:11], v[16:17], v[16:17], v[10:11]
    v_pk_add_f32 v[8:9], v[8:9], v[18:19]
    v_pk_fma_f32 v[10:11], v[18:19], v[18:19], v[10:11]
    buffer_load_dwordx4 v[128:131], v0, s[4:7], s27 offen offset:1024 nt
    s_waitcnt vmcnt(11)
    v_lshlrev_b32 v12, 16, v84
    v_and_b32 v13, s42, v84
    v_lshlrev_b32 v14, 16, v85
    v_and_b32 v15, s42, v85
    v_lshlrev_b32 v16, 16, v86
    v_and_b32 v17, s42, v86
    v_lshlrev_b32 v18, 16, v87
    v_and_b32 v19, s42, v87
    v_pk_add_f32 v[12:13], v[12:13], s[30:31] op_sel_hi:[1,0] neg_lo:[0,1] neg_hi:[0,1]
    v_pk_add_f32 v[14:15], v[14:15], s[30:31] op_sel_hi:[1,0] neg_lo:[0,1] neg_hi:[0,1]
    v_pk_add_f32 v[16:17], v[16:17], s[30:31] op_sel_hi:[1,0] neg_lo:[0,1] neg_hi:[0,1]
    v_pk_add_f32 v[18:19], v[18:19], s[30:31] op_sel_hi:[1,0] neg_lo:[0,1] neg_hi:[0,1]
    v_pk_add_f32 v[8:9], v[8:9], v[12:13]
    v_pk_fma_f32 v[10:11], v[12:13], v[12:13], v[10:11]
    v_pk_add_f32 v[8:9], v[8:9], v[14:15]
    v_pk_fma_f32 v[10:11], v[14:15], v[14:15], v[10:11]
    v_pk_add_f32 v[8:9], v[8:9], v[16:17]
    v_pk_fma_f32 v[10:11], v[16:17], v[16:17], v[10:11]
    v_pk_add_f32 v[8:9], v[8:9], v[18:19]
    v_pk_fma_f32 v[10:11], v[18:19], v[18:19], v[10:11]
    s_add_u32 s27, s27, 131072
    buffer_load_dwordx4 v[132:135], v0, s[4:7], s27 offen nt
    s_waitcnt vmcnt(11)
    v_lshlrev_b32 v12, 16, v88
    v_and_b32 v13, s42, v88
    v_lshlrev_b32 v14, 16, v89
    v_and_b32 v15, s42, v89
    v_lshlrev_b32 v16, 16, v90
    v_and_b32 v17, s42, v90
    v_lshlrev_b32 v18, 16, v91
    v_and_b32 v19, s42, v91
    v_pk_add_f32 v[12:13], v[12:13], s[30:31] op_sel_hi:[1,0] neg_lo:[0,1] neg_hi:[0,1]
    v_pk_add_f32 v[14:15], v[14:15], s[30:31] op_sel_hi:[1,0] neg_lo:[0,1] neg_hi:[0,1]
    v_pk_add_f32 v[16:17], v[16:17], s[30:31] op_sel_hi:[1,0] neg_lo:[0,1] neg_hi:[0,1]
    v_pk_add_f32 v[18:19], v[18:19], s[30:31] op_sel_hi:[1,0] neg_lo:[0,1] neg_hi:[0,1]
    v_pk_add_f32 v[8:9], v[8:9], v[12:13]
    v_pk_fma_f32 v[10:11], v[12:13], v[12:13], v[10:11]
    v_pk_add_f32 v[8:9], v[8:9], v[14:15]
    v_pk_fma_f32 v[10:11], v[14:15], v[14:15], v[10:11]
    v_pk_add_f32 v[8:9], v[8:9], v[16:17]
    v_pk_fma_f32 v[10:11], v[16:17], v[16:17], v[10:11]
    v_pk_add_f32 v[8:9], v[8:9], v[18:19]
    v_pk_fma_f32 v[10:11], v[18:19], v[18:19], v[10:11]
    buffer_load_dwordx4 v[136:139], v0, s[4:7], s27 offen offset:1024 nt
    v_add_f32 v12, v8, v9
    v_add_f32 v14, v10, v11
    s_nop 1
    v_add_f32_dpp v12, v12, v12 row_shr:1 row_mask:0xf bank_mask:0xf
    v_add_f32_dpp v14, v14, v14 row_shr:1 row_mask:0xf bank_mask:0xf
    s_nop 1
    v_add_f32_dpp v12, v12, v12 row_shr:2 row_mask:0xf bank_mask:0xf
    v_add_f32_dpp v14, v14, v14 row_shr:2 row_mask:0xf bank_mask:0xf
    s_nop 1
    v_add_f32_dpp v12, v12, v12 row_shr:4 row_mask:0xf bank_mask:0xf
    v_add_f32_dpp v14, v14, v14 row_shr:4 row_mask:0xf bank_mask:0xf
    s_nop 1
    v_add_f32_dpp v12, v12, v12 row_shr:8 row_mask:0xf bank_mask:0xf
    v_add_f32_dpp v14, v14, v14 row_shr:8 row_mask:0xf bank_mask:0xf
    s_nop 1
    v_add_f32_dpp v12, v12, v12 row_bcast:15 row_mask:0xa bank_mask:0xf
    v_add_f32_dpp v14, v14, v14 row_bcast:15 row_mask:0xa bank_mask:0xf
    s_nop 1
    v_add_f32_dpp v12, v12, v12 row_bcast:31 row_mask:0xc bank_mask:0xf
    v_add_f32_dpp v14, v14, v14 row_bcast:31 row_mask:0xc bank_mask:0xf
    v_readfirstlane_b32 s34, v4
    s_nop 0
    s_mul_i32 s34, s34, 0x9e3779b1
    s_add_u32 s34, s34, 0x85ebca6b
    s_not_b32 s65, s34
    s_xor_b32 s68, s65, s64
    s_or_b32 s69, s65, 1
    v_mov_b32 v13, s34
    v_mov_b32 v15, s65
    s_lshl_b32 s57, s26, 4
    s_add_u32 s57, s57, 147456
    v_mov_b32 v16, s57
    v_subrev_u32 v17, s43, v2
    v_add_u32 v17, 147456, v17
    s_lshl_b64 exec, 1, 63
    ds_write_b128 v16, v[12:15]
    s_mov_b64 exec, 0xff
    ds_read_b128 v[12:15], v17
    s_waitcnt lgkmcnt(0)
    v_cmp_eq_u32 vcc, s34, v13
    v_cmp_eq_u32 s[58:59], s65, v15
    s_nop 0
    s_nop 0
    s_and_b64 vcc, vcc, s[58:59]
    s_cmp_eq_u64 vcc, exec
    s_cbranch_scc0 L_nopub_1
    s_nop 1
    v_add_f32_dpp v12, v12, v12 row_shr:1 row_mask:0xf bank_mask:0xf
    v_add_f32_dpp v14, v14, v14 row_shr:1 row_mask:0xf bank_mask:0xf
    s_nop 1
    v_add_f32_dpp v12, v12, v12 row_shr:2 row_mask:0xf bank_mask:0xf
    v_add_f32_dpp v14, v14, v14 row_shr:2 row_mask:0xf bank_mask:0xf
    s_nop 1
    v_add_f32_dpp v12, v12, v12 row_shr:4 row_mask:0xf bank_mask:0xf
    v_add_f32_dpp v14, v14, v14 row_shr:4 row_mask:0xf bank_mask:0xf
    v_mov_b32 v15, s68
    s_mov_b64 exec, 0x80
    buffer_store_dwordx4 v[12:15], off, s[12:15], s56 sc1
L_nopub_1:
    s_mov_b64 exec, -1
    s_nop 0
    v_mov_b32 v8, 0
    v_mov_b32 v9, 0
    v_mov_b32 v10, 0
    v_mov_b32 v11, 0
    s_waitcnt vmcnt(11)
    v_lshlrev_b32 v12, 16, v92
    v_and_b32 v13, s42, v92
    v_lshlrev_b32 v14, 16, v93
    v_and_b32 v15, s42, v93
    v_lshlrev_b32 v16, 16, v94
    v_and_b32 v17, s42, v94
    v_lshlrev_b32 v18, 16, v95
    v_and_b32 v19, s42, v95
    v_pk_add_f32 v[12:13], v[12:13], s[32:33] op_sel_hi:[1,0] neg_lo:[0,1] neg_hi:[0,1]
    v_pk_add_f32 v[14:15], v[14:15], s[32:33] op_sel_hi:[1,0] neg_lo:[0,1] neg_hi:[0,1]
    v_pk_add_f32 v[16:17], v[16:17], s[32:33] op_sel_hi:[1,0] neg_lo:[0,1] neg_hi:[0,1]
    v_pk_add_f32 v[18:19], v[18:19], s[32:33] op_sel_hi:[1,0] neg_lo:[0,1] neg_hi:[0,1]
    v_pk_add_f32 v[8:9], v[8:9], v[12:13]
    v_pk_fma_f32 v[10:11], v[12:13], v[12:13], v[10:11]
    v_pk_add_f32 v[8:9], v[8:9], v[14:15]
    v_pk_fma_f32 v[10:11], v[14:15], v[14:15], v[10:11]
    v_pk_add_f32 v[8:9], v[8:9], v[16:17]
    v_pk_fma_f32 v[10:11], v[16:17], v[16:17], v[10:11]
    v_pk_add_f32 v[8:9], v[8:9], v[18:19]
    v_pk_fma_f32 v[10:11], v[18:19], v[18:19], v[10:11]
    s_add_u32 s27, s27, 131072
    buffer_load_dwordx4 v[140:143], v0, s[4:7], s27 offen nt
    s_waitcnt vmcnt(11)
    v_lshlrev_b32 v12, 16, v96
    v_and_b32 v13, s42, v96
    v_lshlrev_b32 v14, 16, v97
    v_and_b32 v15, s42, v97
    v_lshlrev_b32 v16, 16, v98
    v_and_b32 v17, s42, v98
    v_lshlrev_b32 v18, 16, v99
    v_and_b32 v19, s42, v99
    v_pk_add_f32 v[12:13], v[12:13], s[32:33] op_sel_hi:[1,0] neg_lo:[0,1] neg_hi:[0,1]
    v_pk_add_f32 v[14:15], v[14:15], s[32:33] op_sel_hi:[1,0] neg_lo:[0,1] neg_hi:[0,1]
    v_pk_add_f32 v[16:17], v[16:17], s[32:33] op_sel_hi:[1,0] neg_lo:[0,1] neg_hi:[0,1]
    v_pk_add_f32 v[18:19], v[18:19], s[32:33] op_sel_hi:[1,0] neg_lo:[0,1] neg_hi:[0,1]
    v_pk_add_f32 v[8:9], v[8:9], v[12:13]
    v_pk_fma_f32 v[10:11], v[12:13], v[12:13], v[10:11]
    v_pk_add_f32 v[8:9], v[8:9], v[14:15]
    v_pk_fma_f32 v[10:11], v[14:15], v[14:15], v[10:11]
    v_pk_add_f32 v[8:9], v[8:9], v[16:17]
    v_pk_fma_f32 v[10:11], v[16:17], v[16:17], v[10:11]
    v_pk_add_f32 v[8:9], v[8:9], v[18:19]
    v_pk_fma_f32 v[10:11], v[18:19], v[18:19], v[10:11]
    buffer_load_dwordx4 v[144:147], v0, s[4:7], s27 offen offset:1024 nt
    s_waitcnt vmcnt(11)
    v_lshlrev_b32 v12, 16, v100
    v_and_b32 v13, s42, v100
    v_lshlrev_b32 v14, 16, v101
    v_and_b32 v15, s42, v101
    v_lshlrev_b32 v16, 16, v102
    v_and_b32 v17, s42, v102
    v_lshlrev_b32 v18, 16, v103
    v_and_b32 v19, s42, v103
    v_pk_add_f32 v[12:13], v[12:13], s[32:33] op_sel_hi:[1,0] neg_lo:[0,1] neg_hi:[0,1]
    v_pk_add_f32 v[14:15], v[14:15], s[32:33] op_sel_hi:[1,0] neg_lo:[0,1] neg_hi:[0,1]
    v_pk_add_f32 v[16:17], v[16:17], s[32:33] op_sel_hi:[1,0] neg_lo:[0,1] neg_hi:[0,1]
    v_pk_add_f32 v[18:19], v[18:19], s[32:33] op_sel_hi:[1,0] neg_lo:[0,1] neg_hi:[0,1]
    v_pk_add_f32 v[8:9], v[8:9], v[12:13]
    v_pk_fma_f32 v[10:11], v[12:13], v[12:13], v[10:11]
    v_pk_add_f32 v[8:9], v[8:9], v[14:15]
    v_pk_fma_f32 v[10:11], v[14:15], v[14:15], v[10:11]
    v_pk_add_f32 v[8:9], v[8:9], v[16:17]
    v_pk_fma_f32 v[10:11], v[16:17], v[16:17], v[10:11]
    v_pk_add_f32 v[8:9], v[8:9], v[18:19]
    v_pk_fma_f32 v[10:11], v[18:19], v[18:19], v[10:11]
    s_add_u32 s27, s27, 131072
    buffer_load_dwordx4 v[148:151], v0, s[4:7], s27 offen nt
    s_waitcnt vmcnt(11)
    v_lshlrev_b32 v12, 16, v104
    v_and_b32 v13, s42, v104
    v_lshlrev_b32 v14, 16, v105
    v_and_b32 v15, s42, v105
    v_lshlrev_b32 v16, 16, v106
    v_and_b32 v17, s42, v106
    v_lshlrev_b32 v18, 16, v107
    v_and_b32 v19, s42, v107
    v_pk_add_f32 v[12:13], v[12:13], s[32:33] op_sel_hi:[1,0] neg_lo:[0,1] neg_hi:[0,1]
    v_pk_add_f32 v[14:15], v[14:15], s[32:33] op_sel_hi:[1,0] neg_lo:[0,1] neg_hi:[0,1]
    v_pk_add_f32 v[16:17], v[16:17], s[32:33] op_sel_hi:[1,0] neg_lo:[0,1] neg_hi:[0,1]
    v_pk_add_f32 v[18:19], v[18:19], s[32:33] op_sel_hi:[1,0] neg_lo:[0,1] neg_hi:[0,1]
    v_pk_add_f32 v[8:9], v[8:9], v[12:13]
    v_pk_fma_f32 v[10:11], v[12:13], v[12:13], v[10:11]
    v_pk_add_f32 v[8:9], v[8:9], v[14:15]
    v_pk_fma_f32 v[10:11], v[14:15], v[14:15], v[10:11]
    v_pk_add_f32 v[8:9], v[8:9], v[16:17]
    v_pk_fma_f32 v[10:11], v[16:17], v[16:17], v[10:11]
    v_pk_add_f32 v[8:9], v[8:9], v[18:19]
    v_pk_fma_f32 v[10:11], v[18:19], v[18:19], v[10:11]
    buffer_load_dwordx4 v[152:155], v0, s[4:7], s27 offen offset:1024 nt
    s_waitcnt vmcnt(11)
    v_lshlrev_b32 v12, 16, v108
    v_and_b32 v13, s42, v108
    v_lshlrev_b32 v14, 16, v109
    v_and_b32 v15, s42, v109
    v_lshlrev_b32 v16, 16, v110
    v_and_b32 v17, s42, v110
    v_lshlrev_b32 v18, 16, v111
    v_and_b32 v19, s42, v111
    v_pk_add_f32 v[12:13], v[12:13], s[32:33] op_sel_hi:[1,0] neg_lo:[0,1] neg_hi:[0,1]
    v_pk_add_f32 v[14:15], v[14:15], s[32:33] op_sel_hi:[1,0] neg_lo:[0,1] neg_hi:[0,1]
    v_pk_add_f32 v[16:17], v[16:17], s[32:33] op_sel_hi:[1,0] neg_lo:[0,1] neg_hi:[0,1]
    v_pk_add_f32 v[18:19], v[18:19], s[32:33] op_sel_hi:[1,0] neg_lo:[0,1] neg_hi:[0,1]
    v_pk_add_f32 v[8:9], v[8:9], v[12:13]
    v_pk_fma_f32 v[10:11], v[12:13], v[12:13], v[10:11]
    v_pk_add_f32 v[8:9], v[8:9], v[14:15]
    v_pk_fma_f32 v[10:11], v[14:15], v[14:15], v[10:11]
    v_pk_add_f32 v[8:9], v[8:9], v[16:17]
    v_pk_fma_f32 v[10:11], v[16:17], v[16:17], v[10:11]
    v_pk_add_f32 v[8:9], v[8:9], v[18:19]
    v_pk_fma_f32 v[10:11], v[18:19], v[18:19], v[10:11]
    s_add_u32 s27, s27, 131072
    buffer_load_dwordx4 v[156:159], v0, s[4:7], s27 offen nt
    s_mov_b64 exec, 0xff
    v_subrev_u32 v16, s43, v2
    buffer_load_dwordx4 v[4:7], v16, s[12:15], s55 offen sc1
    s_mov_b64 exec, -1
    s_waitcnt vmcnt(12)
    v_lshlrev_b32 v12, 16, v112
    v_and_b32 v13, s42, v112
    v_lshlrev_b32 v14, 16, v113
    v_and_b32 v15, s42, v113
    v_lshlrev_b32 v16, 16, v114
    v_and_b32 v17, s42, v114
    v_lshlrev_b32 v18, 16, v115
    v_and_b32 v19, s42, v115
    v_pk_add_f32 v[12:13], v[12:13], s[32:33] op_sel_hi:[1,0] neg_lo:[0,1] neg_hi:[0,1]
    v_pk_add_f32 v[14:15], v[14:15], s[32:33] op_sel_hi:[1,0] neg_lo:[0,1] neg_hi:[0,1]
    v_pk_add_f32 v[16:17], v[16:17], s[32:33] op_sel_hi:[1,0] neg_lo:[0,1] neg_hi:[0,1]
    v_pk_add_f32 v[18:19], v[18:19], s[32:33] op_sel_hi:[1,0] neg_lo:[0,1] neg_hi:[0,1]
    v_pk_add_f32 v[8:9], v[8:9], v[12:13]
    v_pk_fma_f32 v[10:11], v[12:13], v[12:13], v[10:11]
    v_pk_add_f32 v[8:9], v[8:9], v[14:15]
    v_pk_fma_f32 v[10:11], v[14:15], v[14:15], v[10:11]
    v_pk_add_f32 v[8:9], v[8:9], v[16:17]
    v_pk_fma_f32 v[10:11], v[16:17], v[16:17], v[10:11]
    v_pk_add_f32 v[8:9], v[8:9], v[18:19]
    v_pk_fma_f32 v[10:11], v[18:19], v[18:19], v[10:11]
    buffer_load_dwordx4 v[160:163], v0, s[4:7], s27 offen offset:1024 nt
    s_waitcnt vmcnt(12)
    v_lshlrev_b32 v12, 16, v116
    v_and_b32 v13, s42, v116
    v_lshlrev_b32 v14, 16, v117
    v_and_b32 v15, s42, v117
    v_lshlrev_b32 v16, 16, v118
    v_and_b32 v17, s42, v118
    v_lshlrev_b32 v18, 16, v119
    v_and_b32 v19, s42, v119
    v_pk_add_f32 v[12:13], v[12:13], s[32:33] op_sel_hi:[1,0] neg_lo:[0,1] neg_hi:[0,1]
    v_pk_add_f32 v[14:15], v[14:15], s[32:33] op_sel_hi:[1,0] neg_lo:[0,1] neg_hi:[0,1]
    v_pk_add_f32 v[16:17], v[16:17], s[32:33] op_sel_hi:[1,0] neg_lo:[0,1] neg_hi:[0,1]
    v_pk_add_f32 v[18:19], v[18:19], s[32:33] op_sel_hi:[1,0] neg_lo:[0,1] neg_hi:[0,1]
    v_pk_add_f32 v[8:9], v[8:9], v[12:13]
    v_pk_fma_f32 v[10:11], v[12:13], v[12:13], v[10:11]
    v_pk_add_f32 v[8:9], v[8:9], v[14:15]
    v_pk_fma_f32 v[10:11], v[14:15], v[14:15], v[10:11]
    v_pk_add_f32 v[8:9], v[8:9], v[16:17]
    v_pk_fma_f32 v[10:11], v[16:17], v[16:17], v[10:11]
    v_pk_add_f32 v[8:9], v[8:9], v[18:19]
    v_pk_fma_f32 v[10:11], v[18:19], v[18:19], v[10:11]
    s_add_u32 s27, s27, 131072
    buffer_load_dwordx4 v[164:167], v0, s[4:7], s27 offen nt
    s_waitcnt vmcnt(12)
    v_lshlrev_b32 v12, 16, v120
    v_and_b32 v13, s42, v120
    v_lshlrev_b32 v14, 16, v121
    v_and_b32 v15, s42, v121
    v_lshlrev_b32 v16, 16, v122
    v_and_b32 v17, s42, v122
    v_lshlrev_b32 v18, 16, v123
    v_and_b32 v19, s42, v123
    v_pk_add_f32 v[12:13], v[12:13], s[32:33] op_sel_hi:[1,0] neg_lo:[0,1] neg_hi:[0,1]
    v_pk_add_f32 v[14:15], v[14:15], s[32:33] op_sel_hi:[1,0] neg_lo:[0,1] neg_hi:[0,1]
    v_pk_add_f32 v[16:17], v[16:17], s[32:33] op_sel_hi:[1,0] neg_lo:[0,1] neg_hi:[0,1]
    v_pk_add_f32 v[18:19], v[18:19], s[32:33] op_sel_hi:[1,0] neg_lo:[0,1] neg_hi:[0,1]
    v_pk_add_f32 v[8:9], v[8:9], v[12:13]
    v_pk_fma_f32 v[10:11], v[12:13], v[12:13], v[10:11]
    v_pk_add_f32 v[8:9], v[8:9], v[14:15]
    v_pk_fma_f32 v[10:11], v[14:15], v[14:15], v[10:11]
    v_pk_add_f32 v[8:9], v[8:9], v[16:17]
    v_pk_fma_f32 v[10:11], v[16:17], v[16:17], v[10:11]
    v_pk_add_f32 v[8:9], v[8:9], v[18:19]
    v_pk_fma_f32 v[10:11], v[18:19], v[18:19], v[10:11]
    buffer_load_dwordx4 v[168:171], v0, s[4:7], s27 offen offset:1024 nt
    s_waitcnt vmcnt(12)
    v_lshlrev_b32 v12, 16, v124
    v_and_b32 v13, s42, v124
    v_lshlrev_b32 v14, 16, v125
    v_and_b32 v15, s42, v125
    v_lshlrev_b32 v16, 16, v126
    v_and_b32 v17, s42, v126
    v_lshlrev_b32 v18, 16, v127
    v_and_b32 v19, s42, v127
    v_pk_add_f32 v[12:13], v[12:13], s[32:33] op_sel_hi:[1,0] neg_lo:[0,1] neg_hi:[0,1]
    v_pk_add_f32 v[14:15], v[14:15], s[32:33] op_sel_hi:[1,0] neg_lo:[0,1] neg_hi:[0,1]
    v_pk_add_f32 v[16:17], v[16:17], s[32:33] op_sel_hi:[1,0] neg_lo:[0,1] neg_hi:[0,1]
    v_pk_add_f32 v[18:19], v[18:19], s[32:33] op_sel_hi:[1,0] neg_lo:[0,1] neg_hi:[0,1]
    v_pk_add_f32 v[8:9], v[8:9], v[12:13]
    v_pk_fma_f32 v[10:11], v[12:13], v[12:13], v[10:11]
    v_pk_add_f32 v[8:9], v[8:9], v[14:15]
    v_pk_fma_f32 v[10:11], v[14:15], v[14:15], v[10:11]
    v_pk_add_f32 v[8:9], v[8:9], v[16:17]
    v_pk_fma_f32 v[10:11], v[16:17], v[16:17], v[10:11]
    v_pk_add_f32 v[8:9], v[8:9], v[18:19]
    v_pk_fma_f32 v[10:11], v[18:19], v[18:19], v[10:11]
    s_add_u32 s27, s27, 131072
    buffer_load_dwordx4 v[172:175], v0, s[4:7], s27 offen nt
    s_waitcnt vmcnt(12)
    v_lshlrev_b32 v12, 16, v128
    v_and_b32 v13, s42, v128
    v_lshlrev_b32 v14, 16, v129
    v_and_b32 v15, s42, v129
    v_lshlrev_b32 v16, 16, v130
    v_and_b32 v17, s42, v130
    v_lshlrev_b32 v18, 16, v131
    v_and_b32 v19, s42, v131
    v_pk_add_f32 v[12:13], v[12:13], s[32:33] op_sel_hi:[1,0] neg_lo:[0,1] neg_hi:[0,1]
    v_pk_add_f32 v[14:15], v[14:15], s[32:33] op_sel_hi:[1,0] neg_lo:[0,1] neg_hi:[0,1]
    v_pk_add_f32 v[16:17], v[16:17], s[32:33] op_sel_hi:[1,0] neg_lo:[0,1] neg_hi:[0,1]
    v_pk_add_f32 v[18:19], v[18:19], s[32:33] op_sel_hi:[1,0] neg_lo:[0,1] neg_hi:[0,1]
    v_pk_add_f32 v[8:9], v[8:9], v[12:13]
    v_pk_fma_f32 v[10:11], v[12:13], v[12:13], v[10:11]
    v_pk_add_f32 v[8:9], v[8:9], v[14:15]
    v_pk_fma_f32 v[10:11], v[14:15], v[14:15], v[10:11]
    v_pk_add_f32 v[8:9], v[8:9], v[16:17]
    v_pk_fma_f32 v[10:11], v[16:17], v[16:17], v[10:11]
    v_pk_add_f32 v[8:9], v[8:9], v[18:19]
    v_pk_fma_f32 v[10:11], v[18:19], v[18:19], v[10:11]
    buffer_load_dwordx4 v[176:179], v0, s[4:7], s27 offen offset:1024 nt
    s_waitcnt vmcnt(12)
    v_lshlrev_b32 v12, 16, v132
    v_and_b32 v13, s42, v132
    v_lshlrev_b32 v14, 16, v133
    v_and_b32 v15, s42, v133
    v_lshlrev_b32 v16, 16, v134
    v_and_b32 v17, s42, v134
    v_lshlrev_b32 v18, 16, v135
    v_and_b32 v19, s42, v135
    v_pk_add_f32 v[12:13], v[12:13], s[32:33] op_sel_hi:[1,0] neg_lo:[0,1] neg_hi:[0,1]
    v_pk_add_f32 v[14:15], v[14:15], s[32:33] op_sel_hi:[1,0] neg_lo:[0,1] neg_hi:[0,1]
    v_pk_add_f32 v[16:17], v[16:17], s[32:33] op_sel_hi:[1,0] neg_lo:[0,1] neg_hi:[0,1]
    v_pk_add_f32 v[18:19], v[18:19], s[32:33] op_sel_hi:[1,0] neg_lo:[0,1] neg_hi:[0,1]
    v_pk_add_f32 v[8:9], v[8:9], v[12:13]
    v_pk_fma_f32 v[10:11], v[12:13], v[12:13], v[10:11]
    v_pk_add_f32 v[8:9], v[8:9], v[14:15]
    v_pk_fma_f32 v[10:11], v[14:15], v[14:15], v[10:11]
    v_pk_add_f32 v[8:9], v[8:9], v[16:17]
    v_pk_fma_f32 v[10:11], v[16:17], v[16:17], v[10:11]
    v_pk_add_f32 v[8:9], v[8:9], v[18:19]
    v_pk_fma_f32 v[10:11], v[18:19], v[18:19], v[10:11]
    s_add_u32 s27, s27, 131072
    buffer_load_dwordx4 v[180:183], v0, s[4:7], s27 offen nt
    s_waitcnt vmcnt(12)
    v_lshlrev_b32 v12, 16, v136
    v_and_b32 v13, s42, v136
    v_lshlrev_b32 v14, 16, v137
    v_and_b32 v15, s42, v137
    v_lshlrev_b32 v16, 16, v138
    v_and_b32 v17, s42, v138
    v_lshlrev_b32 v18, 16, v139
    v_and_b32 v19, s42, v139
    v_pk_add_f32 v[12:13], v[12:13], s[32:33] op_sel_hi:[1,0] neg_lo:[0,1] neg_hi:[0,1]
    v_pk_add_f32 v[14:15], v[14:15], s[32:33] op_sel_hi:[1,0] neg_lo:[0,1] neg_hi:[0,1]
    v_pk_add_f32 v[16:17], v[16:17], s[32:33] op_sel_hi:[1,0] neg_lo:[0,1] neg_hi:[0,1]
    v_pk_add_f32 v[18:19], v[18:19], s[32:33] op_sel_hi:[1,0] neg_lo:[0,1] neg_hi:[0,1]
    v_pk_add_f32 v[8:9], v[8:9], v[12:13]
    v_pk_fma_f32 v[10:11], v[12:13], v[12:13], v[10:11]
    v_pk_add_f32 v[8:9], v[8:9], v[14:15]
    v_pk_fma_f32 v[10:11], v[14:15], v[14:15], v[10:11]
    v_pk_add_f32 v[8:9], v[8:9], v[16:17]
    v_pk_fma_f32 v[10:11], v[16:17], v[16:17], v[10:11]
    v_pk_add_f32 v[8:9], v[8:9], v[18:19]
    v_pk_fma_f32 v[10:11], v[18:19], v[18:19], v[10:11]
    buffer_load_dwordx4 v[184:187], v0, s[4:7], s27 offen offset:1024 nt
    s_waitcnt vmcnt(12)
    v_lshlrev_b32 v12, 16, v140
    v_and_b32 v13, s42, v140
    v_lshlrev_b32 v14, 16, v141
    v_and_b32 v15, s42, v141
    v_lshlrev_b32 v16, 16, v142
    v_and_b32 v17, s42, v142
    v_lshlrev_b32 v18, 16, v143
    v_and_b32 v19, s42, v143
    v_pk_add_f32 v[12:13], v[12:13], s[32:33] op_sel_hi:[1,0] neg_lo:[0,1] neg_hi:[0,1]
    v_pk_add_f32 v[14:15], v[14:15], s[32:33] op_sel_hi:[1,0] neg_lo:[0,1] neg_hi:[0,1]
    v_pk_add_f32 v[16:17], v[16:17], s[32:33] op_sel_hi:[1,0] neg_lo:[0,1] neg_hi:[0,1]
    v_pk_add_f32 v[18:19], v[18:19], s[32:33] op_sel_hi:[1,0] neg_lo:[0,1] neg_hi:[0,1]
    v_pk_add_f32 v[8:9], v[8:9], v[12:13]
    v_pk_fma_f32 v[10:11], v[12:13], v[12:13], v[10:11]
    v_pk_add_f32 v[8:9], v[8:9], v[14:15]
    v_pk_fma_f32 v[10:11], v[14:15], v[14:15], v[10:11]
    v_pk_add_f32 v[8:9], v[8:9], v[16:17]
    v_pk_fma_f32 v[10:11], v[16:17], v[16:17], v[10:11]
    v_pk_add_f32 v[8:9], v[8:9], v[18:19]
    v_pk_fma_f32 v[10:11], v[18:19], v[18:19], v[10:11]
    s_add_u32 s27, s27, 131072
    buffer_load_dwordx4 v[188:191], v0, s[4:7], s27 offen nt
    s_waitcnt vmcnt(12)
    v_lshlrev_b32 v12, 16, v144
    v_and_b32 v13, s42, v144
    v_lshlrev_b32 v14, 16, v145
    v_and_b32 v15, s42, v145
    v_lshlrev_b32 v16, 16, v146
    v_and_b32 v17, s42, v146
    v_lshlrev_b32 v18, 16, v147
    v_and_b32 v19, s42, v147
    v_pk_add_f32 v[12:13], v[12:13], s[32:33] op_sel_hi:[1,0] neg_lo:[0,1] neg_hi:[0,1]
    v_pk_add_f32 v[14:15], v[14:15], s[32:33] op_sel_hi:[1,0] neg_lo:[0,1] neg_hi:[0,1]
    v_pk_add_f32 v[16:17], v[16:17], s[32:33] op_sel_hi:[1,0] neg_lo:[0,1] neg_hi:[0,1]
    v_pk_add_f32 v[18:19], v[18:19], s[32:33] op_sel_hi:[1,0] neg_lo:[0,1] neg_hi:[0,1]
    v_pk_add_f32 v[8:9], v[8:9], v[12:13]
    v_pk_fma_f32 v[10:11], v[12:13], v[12:13], v[10:11]
    v_pk_add_f32 v[8:9], v[8:9], v[14:15]
    v_pk_fma_f32 v[10:11], v[14:15], v[14:15], v[10:11]
    v_pk_add_f32 v[8:9], v[8:9], v[16:17]
    v_pk_fma_f32 v[10:11], v[16:17], v[16:17], v[10:11]
    v_pk_add_f32 v[8:9], v[8:9], v[18:19]
    v_pk_fma_f32 v[10:11], v[18:19], v[18:19], v[10:11]
    buffer_load_dwordx4 v[192:195], v0, s[4:7], s27 offen offset:1024 nt
    s_waitcnt vmcnt(12)
    v_lshlrev_b32 v12, 16, v148
    v_and_b32 v13, s42, v148
    v_lshlrev_b32 v14, 16, v149
    v_and_b32 v15, s42, v149
    v_lshlrev_b32 v16, 16, v150
    v_and_b32 v17, s42, v150
    v_lshlrev_b32 v18, 16, v151
    v_and_b32 v19, s42, v151
    v_pk_add_f32 v[12:13], v[12:13], s[32:33] op_sel_hi:[1,0] neg_lo:[0,1] neg_hi:[0,1]
    v_pk_add_f32 v[14:15], v[14:15], s[32:33] op_sel_hi:[1,0] neg_lo:[0,1] neg_hi:[0,1]
    v_pk_add_f32 v[16:17], v[16:17], s[32:33] op_sel_hi:[1,0] neg_lo:[0,1] neg_hi:[0,1]
    v_pk_add_f32 v[18:19], v[18:19], s[32:33] op_sel_hi:[1,0] neg_lo:[0,1] neg_hi:[0,1]
    v_pk_add_f32 v[8:9], v[8:9], v[12:13]
    v_pk_fma_f32 v[10:11], v[12:13], v[12:13], v[10:11]
    v_pk_add_f32 v[8:9], v[8:9], v[14:15]
    v_pk_fma_f32 v[10:11], v[14:15], v[14:15], v[10:11]
    v_pk_add_f32 v[8:9], v[8:9], v[16:17]
    v_pk_fma_f32 v[10:11], v[16:17], v[16:17], v[10:11]
    v_pk_add_f32 v[8:9], v[8:9], v[18:19]
    v_pk_fma_f32 v[10:11], v[18:19], v[18:19], v[10:11]
    s_add_u32 s27, s27, 131072
    buffer_load_dwordx4 v[196:199], v0, s[4:7], s27 offen nt
    s_waitcnt vmcnt(12)
    v_lshlrev_b32 v12, 16, v152
    v_and_b32 v13, s42, v152
    v_lshlrev_b32 v14, 16, v153
    v_and_b32 v15, s42, v153
    v_lshlrev_b32 v16, 16, v154
    v_and_b32 v17, s42, v154
    v_lshlrev_b32 v18, 16, v155
    v_and_b32 v19, s42, v155
    v_pk_add_f32 v[12:13], v[12:13], s[32:33] op_sel_hi:[1,0] neg_lo:[0,1] neg_hi:[0,1]
    v_pk_add_f32 v[14:15], v[14:15], s[32:33] op_sel_hi:[1,0] neg_lo:[0,1] neg_hi:[0,1]
    v_pk_add_f32 v[16:17], v[16:17], s[32:33] op_sel_hi:[1,0] neg_lo:[0,1] neg_hi:[0,1]
    v_pk_add_f32 v[18:19], v[18:19], s[32:33] op_sel_hi:[1,0] neg_lo:[0,1] neg_hi:[0,1]
    v_pk_add_f32 v[8:9], v[8:9], v[12:13]
    v_pk_fma_f32 v[10:11], v[12:13], v[12:13], v[10:11]
    v_pk_add_f32 v[8:9], v[8:9], v[14:15]
    v_pk_fma_f32 v[10:11], v[14:15], v[14:15], v[10:11]
    v_pk_add_f32 v[8:9], v[8:9], v[16:17]
    v_pk_fma_f32 v[10:11], v[16:17], v[16:17], v[10:11]
    v_pk_add_f32 v[8:9], v[8:9], v[18:19]
    v_pk_fma_f32 v[10:11], v[18:19], v[18:19], v[10:11]
    buffer_load_dwordx4 v[200:203], v0, s[4:7], s27 offen offset:1024 nt
    s_waitcnt vmcnt(12)
    v_lshlrev_b32 v12, 16, v156
    v_and_b32 v13, s42, v156
    v_lshlrev_b32 v14, 16, v157
    v_and_b32 v15, s42, v157
    v_lshlrev_b32 v16, 16, v158
    v_and_b32 v17, s42, v158
    v_lshlrev_b32 v18, 16, v159
    v_and_b32 v19, s42, v159
    v_pk_add_f32 v[12:13], v[12:13], s[32:33] op_sel_hi:[1,0] neg_lo:[0,1] neg_hi:[0,1]
    v_pk_add_f32 v[14:15], v[14:15], s[32:33] op_sel_hi:[1,0] neg_lo:[0,1] neg_hi:[0,1]
    v_pk_add_f32 v[16:17], v[16:17], s[32:33] op_sel_hi:[1,0] neg_lo:[0,1] neg_hi:[0,1]
    v_pk_add_f32 v[18:19], v[18:19], s[32:33] op_sel_hi:[1,0] neg_lo:[0,1] neg_hi:[0,1]
    v_pk_add_f32 v[8:9], v[8:9], v[12:13]
    v_pk_fma_f32 v[10:11], v[12:13], v[12:13], v[10:11]
    v_pk_add_f32 v[8:9], v[8:9], v[14:15]
    v_pk_fma_f32 v[10:11], v[14:15], v[14:15], v[10:11]
    v_pk_add_f32 v[8:9], v[8:9], v[16:17]
    v_pk_fma_f32 v[10:11], v[16:17], v[16:17], v[10:11]
    v_pk_add_f32 v[8:9], v[8:9], v[18:19]
    v_pk_fma_f32 v[10:11], v[18:19], v[18:19], v[10:11]
    s_waitcnt vmcnt(10)
    v_lshlrev_b32 v12, 16, v160
    v_and_b32 v13, s42, v160
    v_lshlrev_b32 v14, 16, v161
    v_and_b32 v15, s42, v161
    v_lshlrev_b32 v16, 16, v162
    v_and_b32 v17, s42, v162
    v_lshlrev_b32 v18, 16, v163
    v_and_b32 v19, s42, v163
    v_pk_add_f32 v[12:13], v[12:13], s[32:33] op_sel_hi:[1,0] neg_lo:[0,1] neg_hi:[0,1]
    v_pk_add_f32 v[14:15], v[14:15], s[32:33] op_sel_hi:[1,0] neg_lo:[0,1] neg_hi:[0,1]
    v_pk_add_f32 v[16:17], v[16:17], s[32:33] op_sel_hi:[1,0] neg_lo:[0,1] neg_hi:[0,1]
    v_pk_add_f32 v[18:19], v[18:19], s[32:33] op_sel_hi:[1,0] neg_lo:[0,1] neg_hi:[0,1]
    v_pk_add_f32 v[8:9], v[8:9], v[12:13]
    v_pk_fma_f32 v[10:11], v[12:13], v[12:13], v[10:11]
    v_pk_add_f32 v[8:9], v[8:9], v[14:15]
    v_pk_fma_f32 v[10:11], v[14:15], v[14:15], v[10:11]
    v_pk_add_f32 v[8:9], v[8:9], v[16:17]
    v_pk_fma_f32 v[10:11], v[16:17], v[16:17], v[10:11]
    v_pk_add_f32 v[8:9], v[8:9], v[18:19]
    v_pk_fma_f32 v[10:11], v[18:19], v[18:19], v[10:11]
    s_mov_b32 s57, 20000
    s_mov_b64 exec, 0xff
L_chk_2:
    v_cmp_eq_u32 vcc, s34, v5
    v_or_b32 v14, 1, v7
    v_cmp_eq_u32 s[58:59], s69, v14
    s_nop 1
    s_and_b64 vcc, vcc, s[58:59]
    s_cmp_eq_u64 vcc, exec
    s_cbranch_scc1 L_ok_3
    s_sub_u32 s57, s57, 1
    s_cmp_eq_u32 s57, 0
    s_cbranch_scc1 L_ok_3
    s_sleep 8
    v_subrev_u32 v16, s43, v2
    buffer_load_dwordx4 v[4:7], v16, s[12:15], s55 offen sc1
    s_waitcnt vmcnt(0)
    s_branch L_chk_2
L_ok_3:
    s_nop 1
    v_add_f32_dpp v4, v4, v4 row_shr:1 row_mask:0xf bank_mask:0xf
    v_add_f32_dpp v6, v6, v6 row_shr:1 row_mask:0xf bank_mask:0xf
    s_nop 1
    v_add_f32_dpp v4, v4, v4 row_shr:2 row_mask:0xf bank_mask:0xf
    v_add_f32_dpp v6, v6, v6 row_shr:2 row_mask:0xf bank_mask:0xf
    s_nop 1
    v_add_f32_dpp v4, v4, v4 row_shr:4 row_mask:0xf bank_mask:0xf
    v_add_f32_dpp v6, v6, v6 row_shr:4 row_mask:0xf bank_mask:0xf
    s_mov_b64 exec, -1
    s_nop 1
    v_readlane_b32 s58, v4, 7
    v_readlane_b32 s59, v6, 7
    s_xor_b32 s57, s25, 1
    v_readlane_b32 s40, v7, s25
    v_readlane_b32 s41, v7, s57
    s_nop 0
    s_xor_b32 s40, s40, s65
    s_xor_b32 s41, s41, s65
    s_and_b32 s40, s40, 1
    s_and_b32 s41, s41, 1
    s_and_b32 s33, s25, 1
    s_cmp_eq_u32 s40, s41
    s_cselect_b32 s33, s33, s40
    s_mov_b32 s57, 0x35638e39
    v_mov_b32 v12, s58
    v_mov_b32 v13, s59
    v_mul_f32 v12, s57, v12
    v_mul_f32 v13, s57, v13
    v_fma_f32 v13, -v12, v12, v13
    v_max_f32 v13, 0, v13
    v_add_f32 v13, 0x3727c5ac, v13
    v_rsq_f32 v13, v13
    v_add_f32 v12, s30, v12
    v_lshlrev_b32 v14, 16, v3
    v_and_b32 v15, s42, v3
    v_mul_f32 v4, v14, v13
    v_fma_f32 v5, -v12, v4, v15
    s_or_b32 s57, s25, s26
    s_cmp_lg_u32 s57, 0
    s_cbranch_scc1 L_noep_4
    v_mov_b32 v14, s34
    buffer_store_dword v14, off, s[12:15], s54 sc1
    s_nop 1
L_noep_4:
    s_cmp_lg_u32 s33, 0
    s_cbranch_scc1 L_role1
    s_lshr_b32 s40, s25, 1
    s_lshl_b32 s40, s40, 15
    s_mul_i32 s41, s26, 3072
    s_add_u32 s40, s40, s41
    v_subrev_u32 v1, s43, v2
    v_add_u32 v1, s40, v1
    s_add_u32 s27, s27, 131072
    buffer_load_dwordx4 v[204:207], v1, s[4:7], s27 offen nt
    buffer_load_dwordx4 v[208:211], v1, s[4:7], s27 offen offset:1024 nt
    s_waitcnt vmcnt(11)
    v_lshlrev_b32 v12, 16, v164
    v_and_b32 v13, s42, v164
    v_lshlrev_b32 v14, 16, v165
    v_and_b32 v15, s42, v165
    v_lshlrev_b32 v16, 16, v166
    v_and_b32 v17, s42, v166
    v_lshlrev_b32 v18, 16, v167
    v_and_b32 v19, s42, v167
    v_pk_add_f32 v[12:13], v[12:13], s[32:33] op_sel_hi:[1,0] neg_lo:[0,1] neg_hi:[0,1]
    v_pk_add_f32 v[14:15], v[14:15], s[32:33] op_sel_hi:[1,0] neg_lo:[0,1] neg_hi:[0,1]
    v_pk_add_f32 v[16:17], v[16:17], s[32:33] op_sel_hi:[1,0] neg_lo:[0,1] neg_hi:[0,1]
    v_pk_add_f32 v[18:19], v[18:19], s[32:33] op_sel_hi:[1,0] neg_lo:[0,1] neg_hi:[0,1]
    v_pk_add_f32 v[8:9], v[8:9], v[12:13]
    v_pk_fma_f32 v[10:11], v[12:13], v[12:13], v[10:11]
    v_pk_add_f32 v[8:9], v[8:9], v[14:15]
    v_pk_fma_f32 v[10:11], v[14:15], v[14:15], v[10:11]
    v_pk_add_f32 v[8:9], v[8:9], v[16:17]
    v_pk_fma_f32 v[10:11], v[16:17], v[16:17], v[10:11]
    v_pk_add_f32 v[8:9], v[8:9], v[18:19]
    v_pk_fma_f32 v[10:11], v[18:19], v[18:19], v[10:11]
    buffer_load_dwordx4 v[212:215], v1, s[4:7], s27 offen offset:2048 nt
    s_waitcnt vmcnt(11)
    v_lshlrev_b32 v12, 16, v168
    v_and_b32 v13, s42, v168
    v_lshlrev_b32 v14, 16, v169
    v_and_b32 v15, s42, v169
    v_lshlrev_b32 v16, 16, v170
    v_and_b32 v17, s42, v170
    v_lshlrev_b32 v18, 16, v171
    v_and_b32 v19, s42, v171
    v_pk_add_f32 v[12:13], v[12:13], s[32:33] op_sel_hi:[1,0] neg_lo:[0,1] neg_hi:[0,1]
    v_pk_add_f32 v[14:15], v[14:15], s[32:33] op_sel_hi:[1,0] neg_lo:[0,1] neg_hi:[0,1]
    v_pk_add_f32 v[16:17], v[16:17], s[32:33] op_sel_hi:[1,0] neg_lo:[0,1] neg_hi:[0,1]
    v_pk_add_f32 v[18:19], v[18:19], s[32:33] op_sel_hi:[1,0] neg_lo:[0,1] neg_hi:[0,1]
    v_pk_add_f32 v[8:9], v[8:9], v[12:13]
    v_pk_fma_f32 v[10:11], v[12:13], v[12:13], v[10:11]
    v_pk_add_f32 v[8:9], v[8:9], v[14:15]
    v_pk_fma_f32 v[10:11], v[14:15], v[14:15], v[10:11]
    v_pk_add_f32 v[8:9], v[8:9], v[16:17]
    v_pk_fma_f32 v[10:11], v[16:17], v[16:17], v[10:11]
    v_pk_add_f32 v[8:9], v[8:9], v[18:19]
    v_pk_fma_f32 v[10:11], v[18:19], v[18:19], v[10:11]
    s_add_u32 s27, s27, 131072
    buffer_load_dwordx4 v[216:219], v1, s[4:7], s27 offen nt
    s_waitcnt vmcnt(11)
    v_lshlrev_b32 v12, 16, v172
    v_and_b32 v13, s42, v172
    v_lshlrev_b32 v14, 16, v173
    v_and_b32 v15, s42, v173
    v_lshlrev_b32 v16, 16, v174
    v_and_b32 v17, s42, v174
    v_lshlrev_b32 v18, 16, v175
    v_and_b32 v19, s42, v175
    v_pk_add_f32 v[12:13], v[12:13], s[32:33] op_sel_hi:[1,0] neg_lo:[0,1] neg_hi:[0,1]
    v_pk_add_f32 v[14:15], v[14:15], s[32:33] op_sel_hi:[1,0] neg_lo:[0,1] neg_hi:[0,1]
    v_pk_add_f32 v[16:17], v[16:17], s[32:33] op_sel_hi:[1,0] neg_lo:[0,1] neg_hi:[0,1]
    v_pk_add_f32 v[18:19], v[18:19], s[32:33] op_sel_hi:[1,0] neg_lo:[0,1] neg_hi:[0,1]
    v_pk_add_f32 v[8:9], v[8:9], v[12:13]
    v_pk_fma_f32 v[10:11], v[12:13], v[12:13], v[10:11]
    v_pk_add_f32 v[8:9], v[8:9], v[14:15]
    v_pk_fma_f32 v[10:11], v[14:15], v[14:15], v[10:11]
    v_pk_add_f32 v[8:9], v[8:9], v[16:17]
    v_pk_fma_f32 v[10:11], v[16:17], v[16:17], v[10:11]
    v_pk_add_f32 v[8:9], v[8:9], v[18:19]
    v_pk_fma_f32 v[10:11], v[18:19], v[18:19], v[10:11]
    buffer_load_dwordx4 v[220:223], v1, s[4:7], s27 offen offset:1024 nt
    s_waitcnt vmcnt(11)
    v_lshlrev_b32 v12, 16, v176
    v_and_b32 v13, s42, v176
    v_lshlrev_b32 v14, 16, v177
    v_and_b32 v15, s42, v177
    v_lshlrev_b32 v16, 16, v178
    v_and_b32 v17, s42, v178
    v_lshlrev_b32 v18, 16, v179
    v_and_b32 v19, s42, v179
    v_pk_add_f32 v[12:13], v[12:13], s[32:33] op_sel_hi:[1,0] neg_lo:[0,1] neg_hi:[0,1]
    v_pk_add_f32 v[14:15], v[14:15], s[32:33] op_sel_hi:[1,0] neg_lo:[0,1] neg_hi:[0,1]
    v_pk_add_f32 v[16:17], v[16:17], s[32:33] op_sel_hi:[1,0] neg_lo:[0,1] neg_hi:[0,1]
    v_pk_add_f32 v[18:19], v[18:19], s[32:33] op_sel_hi:[1,0] neg_lo:[0,1] neg_hi:[0,1]
    v_pk_add_f32 v[8:9], v[8:9], v[12:13]
    v_pk_fma_f32 v[10:11], v[12:13], v[12:13], v[10:11]
    v_pk_add_f32 v[8:9], v[8:9], v[14:15]
    v_pk_fma_f32 v[10:11], v[14:15], v[14:15], v[10:11]
    v_pk_add_f32 v[8:9], v[8:9], v[16:17]
    v_pk_fma_f32 v[10:11], v[16:17], v[16:17], v[10:11]
    v_pk_add_f32 v[8:9], v[8:9], v[18:19]
    v_pk_fma_f32 v[10:11], v[18:19], v[18:19], v[10:11]
    buffer_load_dwordx4 v[224:227], v1, s[4:7], s27 offen offset:2048 nt
    s_waitcnt vmcnt(11)
    v_lshlrev_b32 v12, 16, v180
    v_and_b32 v13, s42, v180
    v_lshlrev_b32 v14, 16, v181
    v_and_b32 v15, s42, v181
    v_lshlrev_b32 v16, 16, v182
    v_and_b32 v17, s42, v182
    v_lshlrev_b32 v18, 16, v183
    v_and_b32 v19, s42, v183
    v_pk_add_f32 v[12:13], v[12:13], s[32:33] op_sel_hi:[1,0] neg_lo:[0,1] neg_hi:[0,1]
    v_pk_add_f32 v[14:15], v[14:15], s[32:33] op_sel_hi:[1,0] neg_lo:[0,1] neg_hi:[0,1]
    v_pk_add_f32 v[16:17], v[16:17], s[32:33] op_sel_hi:[1,0] neg_lo:[0,1] neg_hi:[0,1]
    v_pk_add_f32 v[18:19], v[18:19], s[32:33] op_sel_hi:[1,0] neg_lo:[0,1] neg_hi:[0,1]
    v_pk_add_f32 v[8:9], v[8:9], v[12:13]
    v_pk_fma_f32 v[10:11], v[12:13], v[12:13], v[10:11]
    v_pk_add_f32 v[8:9], v[8:9], v[14:15]
    v_pk_fma_f32 v[10:11], v[14:15], v[14:15], v[10:11]
    v_pk_add_f32 v[8:9], v[8:9], v[16:17]
    v_pk_fma_f32 v[10:11], v[16:17], v[16:17], v[10:11]
    v_pk_add_f32 v[8:9], v[8:9], v[18:19]
    v_pk_fma_f32 v[10:11], v[18:19], v[18:19], v[10:11]
    s_add_u32 s27, s27, 131072
    buffer_load_dwordx4 v[228:231], v1, s[4:7], s27 offen nt
    s_waitcnt vmcnt(11)
    v_lshlrev_b32 v12, 16, v184
    v_and_b32 v13, s42, v184
    v_lshlrev_b32 v14, 16, v185
    v_and_b32 v15, s42, v185
    v_lshlrev_b32 v16, 16, v186
    v_and_b32 v17, s42, v186
    v_lshlrev_b32 v18, 16, v187
    v_and_b32 v19, s42, v187
    v_pk_add_f32 v[12:13], v[12:13], s[32:33] op_sel_hi:[1,0] neg_lo:[0,1] neg_hi:[0,1]
    v_pk_add_f32 v[14:15], v[14:15], s[32:33] op_sel_hi:[1,0] neg_lo:[0,1] neg_hi:[0,1]
    v_pk_add_f32 v[16:17], v[16:17], s[32:33] op_sel_hi:[1,0] neg_lo:[0,1] neg_hi:[0,1]
    v_pk_add_f32 v[18:19], v[18:19], s[32:33] op_sel_hi:[1,0] neg_lo:[0,1] neg_hi:[0,1]
    v_pk_add_f32 v[8:9], v[8:9], v[12:13]
    v_pk_fma_f32 v[10:11], v[12:13], v[12:13], v[10:11]
    v_pk_add_f32 v[8:9], v[8:9], v[14:15]
    v_pk_fma_f32 v[10:11], v[14:15], v[14:15], v[10:11]
    v_pk_add_f32 v[8:9], v[8:9], v[16:17]
    v_pk_fma_f32 v[10:11], v[16:17], v[16:17], v[10:11]
    v_pk_add_f32 v[8:9], v[8:9], v[18:19]
    v_pk_fma_f32 v[10:11], v[18:19], v[18:19], v[10:11]
    buffer_load_dwordx4 v[232:235], v1, s[4:7], s27 offen offset:1024 nt
    s_waitcnt vmcnt(11)
    v_lshlrev_b32 v12, 16, v188
    v_and_b32 v13, s42, v188
    v_lshlrev_b32 v14, 16, v189
    v_and_b32 v15, s42, v189
    v_lshlrev_b32 v16, 16, v190
    v_and_b32 v17, s42, v190
    v_lshlrev_b32 v18, 16, v191
    v_and_b32 v19, s42, v191
    v_pk_add_f32 v[12:13], v[12:13], s[32:33] op_sel_hi:[1,0] neg_lo:[0,1] neg_hi:[0,1]
    v_pk_add_f32 v[14:15], v[14:15], s[32:33] op_sel_hi:[1,0] neg_lo:[0,1] neg_hi:[0,1]
    v_pk_add_f32 v[16:17], v[16:17], s[32:33] op_sel_hi:[1,0] neg_lo:[0,1] neg_hi:[0,1]
    v_pk_add_f32 v[18:19], v[18:19], s[32:33] op_sel_hi:[1,0] neg_lo:[0,1] neg_hi:[0,1]
    v_pk_add_f32 v[8:9], v[8:9], v[12:13]
    v_pk_fma_f32 v[10:11], v[12:13], v[12:13], v[10:11]
    v_pk_add_f32 v[8:9], v[8:9], v[14:15]
    v_pk_fma_f32 v[10:11], v[14:15], v[14:15], v[10:11]
    v_pk_add_f32 v[8:9], v[8:9], v[16:17]
    v_pk_fma_f32 v[10:11], v[16:17], v[16:17], v[10:11]
    v_pk_add_f32 v[8:9], v[8:9], v[18:19]
    v_pk_fma_f32 v[10:11], v[18:19], v[18:19], v[10:11]
    buffer_load_dwordx4 v[236:239], v1, s[4:7], s27 offen offset:2048 nt
    s_waitcnt vmcnt(11)
    v_lshlrev_b32 v12, 16, v192
    v_and_b32 v13, s42, v192
    v_lshlrev_b32 v14, 16, v193
    v_and_b32 v15, s42, v193
    v_lshlrev_b32 v16, 16, v194
    v_and_b32 v17, s42, v194
    v_lshlrev_b32 v18, 16, v195
    v_and_b32 v19, s42, v195
    v_pk_add_f32 v[12:13], v[12:13], s[32:33] op_sel_hi:[1,0] neg_lo:[0,1] neg_hi:[0,1]
    v_pk_add_f32 v[14:15], v[14:15], s[32:33] op_sel_hi:[1,0] neg_lo:[0,1] neg_hi:[0,1]
    v_pk_add_f32 v[16:17], v[16:17], s[32:33] op_sel_hi:[1,0] neg_lo:[0,1] neg_hi:[0,1]
    v_pk_add_f32 v[18:19], v[18:19], s[32:33] op_sel_hi:[1,0] neg_lo:[0,1] neg_hi:[0,1]
    v_pk_add_f32 v[8:9], v[8:9], v[12:13]
    v_pk_fma_f32 v[10:11], v[12:13], v[12:13], v[10:11]
    v_pk_add_f32 v[8:9], v[8:9], v[14:15]
    v_pk_fma_f32 v[10:11], v[14:15], v[14:15], v[10:11]
    v_pk_add_f32 v[8:9], v[8:9], v[16:17]
    v_pk_fma_f32 v[10:11], v[16:17], v[16:17], v[10:11]
    v_pk_add_f32 v[8:9], v[8:9], v[18:19]
    v_pk_fma_f32 v[10:11], v[18:19], v[18:19], v[10:11]
    s_add_u32 s27, s27, 131072
    buffer_load_dwordx4 v[240:243], v1, s[4:7], s27 offen nt
    s_waitcnt vmcnt(11)
    v_lshlrev_b32 v12, 16, v196
    v_and_b32 v13, s42, v196
    v_lshlrev_b32 v14, 16, v197
    v_and_b32 v15, s42, v197
    v_lshlrev_b32 v16, 16, v198
    v_and_b32 v17, s42, v198
    v_lshlrev_b32 v18, 16, v199
    v_and_b32 v19, s42, v199
    v_pk_add_f32 v[12:13], v[12:13], s[32:33] op_sel_hi:[1,0] neg_lo:[0,1] neg_hi:[0,1]
    v_pk_add_f32 v[14:15], v[14:15], s[32:33] op_sel_hi:[1,0] neg_lo:[0,1] neg_hi:[0,1]
    v_pk_add_f32 v[16:17], v[16:17], s[32:33] op_sel_hi:[1,0] neg_lo:[0,1] neg_hi:[0,1]
    v_pk_add_f32 v[18:19], v[18:19], s[32:33] op_sel_hi:[1,0] neg_lo:[0,1] neg_hi:[0,1]
    v_pk_add_f32 v[8:9], v[8:9], v[12:13]
    v_pk_fma_f32 v[10:11], v[12:13], v[12:13], v[10:11]
    v_pk_add_f32 v[8:9], v[8:9], v[14:15]
    v_pk_fma_f32 v[10:11], v[14:15], v[14:15], v[10:11]
    v_pk_add_f32 v[8:9], v[8:9], v[16:17]
    v_pk_fma_f32 v[10:11], v[16:17], v[16:17], v[10:11]
    v_pk_add_f32 v[8:9], v[8:9], v[18:19]
    v_pk_fma_f32 v[10:11], v[18:19], v[18:19], v[10:11]
    buffer_load_dwordx4 v[244:247], v1, s[4:7], s27 offen offset:1024 nt
    s_waitcnt vmcnt(11)
    v_lshlrev_b32 v12, 16, v200
    v_and_b32 v13, s42, v200
    v_lshlrev_b32 v14, 16, v201
    v_and_b32 v15, s42, v201
    v_lshlrev_b32 v16, 16, v202
    v_and_b32 v17, s42, v202
    v_lshlrev_b32 v18, 16, v203
    v_and_b32 v19, s42, v203
    v_pk_add_f32 v[12:13], v[12:13], s[32:33] op_sel_hi:[1,0] neg_lo:[0,1] neg_hi:[0,1]
    v_pk_add_f32 v[14:15], v[14:15], s[32:33] op_sel_hi:[1,0] neg_lo:[0,1] neg_hi:[0,1]
    v_pk_add_f32 v[16:17], v[16:17], s[32:33] op_sel_hi:[1,0] neg_lo:[0,1] neg_hi:[0,1]
    v_pk_add_f32 v[18:19], v[18:19], s[32:33] op_sel_hi:[1,0] neg_lo:[0,1] neg_hi:[0,1]
    v_pk_add_f32 v[8:9], v[8:9], v[12:13]
    v_pk_fma_f32 v[10:11], v[12:13], v[12:13], v[10:11]
    v_pk_add_f32 v[8:9], v[8:9], v[14:15]
    v_pk_fma_f32 v[10:11], v[14:15], v[14:15], v[10:11]
    v_pk_add_f32 v[8:9], v[8:9], v[16:17]
    v_pk_fma_f32 v[10:11], v[16:17], v[16:17], v[10:11]
    v_pk_add_f32 v[8:9], v[8:9], v[18:19]
    v_pk_fma_f32 v[10:11], v[18:19], v[18:19], v[10:11]
    buffer_load_dwordx4 v[248:251], v1, s[4:7], s27 offen offset:2048 nt
    s_waitcnt vmcnt(11)
    v_lshlrev_b32 v12, 16, v204
    v_and_b32 v13, s42, v204
    v_lshlrev_b32 v14, 16, v205
    v_and_b32 v15, s42, v205
    v_lshlrev_b32 v16, 16, v206
    v_and_b32 v17, s42, v206
    v_lshlrev_b32 v18, 16, v207
    v_and_b32 v19, s42, v207
    v_pk_add_f32 v[12:13], v[12:13], s[32:33] op_sel_hi:[1,0] neg_lo:[0,1] neg_hi:[0,1]
    v_pk_add_f32 v[14:15], v[14:15], s[32:33] op_sel_hi:[1,0] neg_lo:[0,1] neg_hi:[0,1]
    v_pk_add_f32 v[16:17], v[16:17], s[32:33] op_sel_hi:[1,0] neg_lo:[0,1] neg_hi:[0,1]
    v_pk_add_f32 v[18:19], v[18:19], s[32:33] op_sel_hi:[1,0] neg_lo:[0,1] neg_hi:[0,1]
    v_pk_add_f32 v[8:9], v[8:9], v[12:13]
    v_pk_fma_f32 v[10:11], v[12:13], v[12:13], v[10:11]
    v_pk_add_f32 v[8:9], v[8:9], v[14:15]
    v_pk_fma_f32 v[10:11], v[14:15], v[14:15], v[10:11]
    v_pk_add_f32 v[8:9], v[8:9], v[16:17]
    v_pk_fma_f32 v[10:11], v[16:17], v[16:17], v[10:11]
    v_pk_add_f32 v[8:9], v[8:9], v[18:19]
    v_pk_fma_f32 v[10:11], v[18:19], v[18:19], v[10:11]
    s_waitcnt vmcnt(10)
    v_lshlrev_b32 v12, 16, v208
    v_and_b32 v13, s42, v208
    v_lshlrev_b32 v14, 16, v209
    v_and_b32 v15, s42, v209
    v_lshlrev_b32 v16, 16, v210
    v_and_b32 v17, s42, v210
    v_lshlrev_b32 v18, 16, v211
    v_and_b32 v19, s42, v211
    v_pk_add_f32 v[12:13], v[12:13], s[32:33] op_sel_hi:[1,0] neg_lo:[0,1] neg_hi:[0,1]
    v_pk_add_f32 v[14:15], v[14:15], s[32:33] op_sel_hi:[1,0] neg_lo:[0,1] neg_hi:[0,1]
    v_pk_add_f32 v[16:17], v[16:17], s[32:33] op_sel_hi:[1,0] neg_lo:[0,1] neg_hi:[0,1]
    v_pk_add_f32 v[18:19], v[18:19], s[32:33] op_sel_hi:[1,0] neg_lo:[0,1] neg_hi:[0,1]
    v_pk_add_f32 v[8:9], v[8:9], v[12:13]
    v_pk_fma_f32 v[10:11], v[12:13], v[12:13], v[10:11]
    v_pk_add_f32 v[8:9], v[8:9], v[14:15]
    v_pk_fma_f32 v[10:11], v[14:15], v[14:15], v[10:11]
    v_pk_add_f32 v[8:9], v[8:9], v[16:17]
    v_pk_fma_f32 v[10:11], v[16:17], v[16:17], v[10:11]
    v_pk_add_f32 v[8:9], v[8:9], v[18:19]
    v_pk_fma_f32 v[10:11], v[18:19], v[18:19], v[10:11]
    s_waitcnt vmcnt(9)
    v_lshlrev_b32 v12, 16, v212
    v_and_b32 v13, s42, v212
    v_lshlrev_b32 v14, 16, v213
    v_and_b32 v15, s42, v213
    v_lshlrev_b32 v16, 16, v214
    v_and_b32 v17, s42, v214
    v_lshlrev_b32 v18, 16, v215
    v_and_b32 v19, s42, v215
    v_pk_add_f32 v[12:13], v[12:13], s[32:33] op_sel_hi:[1,0] neg_lo:[0,1] neg_hi:[0,1]
    v_pk_add_f32 v[14:15], v[14:15], s[32:33] op_sel_hi:[1,0] neg_lo:[0,1] neg_hi:[0,1]
    v_pk_add_f32 v[16:17], v[16:17], s[32:33] op_sel_hi:[1,0] neg_lo:[0,1] neg_hi:[0,1]
    v_pk_add_f32 v[18:19], v[18:19], s[32:33] op_sel_hi:[1,0] neg_lo:[0,1] neg_hi:[0,1]
    v_pk_add_f32 v[8:9], v[8:9], v[12:13]
    v_pk_fma_f32 v[10:11], v[12:13], v[12:13], v[10:11]
    v_pk_add_f32 v[8:9], v[8:9], v[14:15]
    v_pk_fma_f32 v[10:11], v[14:15], v[14:15], v[10:11]
    v_pk_add_f32 v[8:9], v[8:9], v[16:17]
    v_pk_fma_f32 v[10:11], v[16:17], v[16:17], v[10:11]
    v_pk_add_f32 v[8:9], v[8:9], v[18:19]
    v_pk_fma_f32 v[10:11], v[18:19], v[18:19], v[10:11]
    s_waitcnt vmcnt(8)
    v_lshlrev_b32 v12, 16, v216
    v_and_b32 v13, s42, v216
    v_lshlrev_b32 v14, 16, v217
    v_and_b32 v15, s42, v217
    v_lshlrev_b32 v16, 16, v218
    v_and_b32 v17, s42, v218
    v_lshlrev_b32 v18, 16, v219
    v_and_b32 v19, s42, v219
    v_pk_add_f32 v[12:13], v[12:13], s[32:33] op_sel_hi:[1,0] neg_lo:[0,1] neg_hi:[0,1]
    v_pk_add_f32 v[14:15], v[14:15], s[32:33] op_sel_hi:[1,0] neg_lo:[0,1] neg_hi:[0,1]
    v_pk_add_f32 v[16:17], v[16:17], s[32:33] op_sel_hi:[1,0] neg_lo:[0,1] neg_hi:[0,1]
    v_pk_add_f32 v[18:19], v[18:19], s[32:33] op_sel_hi:[1,0] neg_lo:[0,1] neg_hi:[0,1]
    v_pk_add_f32 v[8:9], v[8:9], v[12:13]
    v_pk_fma_f32 v[10:11], v[12:13], v[12:13], v[10:11]
    v_pk_add_f32 v[8:9], v[8:9], v[14:15]
    v_pk_fma_f32 v[10:11], v[14:15], v[14:15], v[10:11]
    v_pk_add_f32 v[8:9], v[8:9], v[16:17]
    v_pk_fma_f32 v[10:11], v[16:17], v[16:17], v[10:11]
    v_pk_add_f32 v[8:9], v[8:9], v[18:19]
    v_pk_fma_f32 v[10:11], v[18:19], v[18:19], v[10:11]
    s_waitcnt vmcnt(7)
    v_lshlrev_b32 v12, 16, v220
    v_and_b32 v13, s42, v220
    v_lshlrev_b32 v14, 16, v221
    v_and_b32 v15, s42, v221
    v_lshlrev_b32 v16, 16, v222
    v_and_b32 v17, s42, v222
    v_lshlrev_b32 v18, 16, v223
    v_and_b32 v19, s42, v223
    v_pk_add_f32 v[12:13], v[12:13], s[32:33] op_sel_hi:[1,0] neg_lo:[0,1] neg_hi:[0,1]
    v_pk_add_f32 v[14:15], v[14:15], s[32:33] op_sel_hi:[1,0] neg_lo:[0,1] neg_hi:[0,1]
    v_pk_add_f32 v[16:17], v[16:17], s[32:33] op_sel_hi:[1,0] neg_lo:[0,1] neg_hi:[0,1]
    v_pk_add_f32 v[18:19], v[18:19], s[32:33] op_sel_hi:[1,0] neg_lo:[0,1] neg_hi:[0,1]
    v_pk_add_f32 v[8:9], v[8:9], v[12:13]
    v_pk_fma_f32 v[10:11], v[12:13], v[12:13], v[10:11]
    v_pk_add_f32 v[8:9], v[8:9], v[14:15]
    v_pk_fma_f32 v[10:11], v[14:15], v[14:15], v[10:11]
    v_pk_add_f32 v[8:9], v[8:9], v[16:17]
    v_pk_fma_f32 v[10:11], v[16:17], v[16:17], v[10:11]
    v_pk_add_f32 v[8:9], v[8:9], v[18:19]
    v_pk_fma_f32 v[10:11], v[18:19], v[18:19], v[10:11]
    s_waitcnt vmcnt(6)
    v_lshlrev_b32 v12, 16, v224
    v_and_b32 v13, s42, v224
    v_lshlrev_b32 v14, 16, v225
    v_and_b32 v15, s42, v225
    v_lshlrev_b32 v16, 16, v226
    v_and_b32 v17, s42, v226
    v_lshlrev_b32 v18, 16, v227
    v_and_b32 v19, s42, v227
    v_pk_add_f32 v[12:13], v[12:13], s[32:33] op_sel_hi:[1,0] neg_lo:[0,1] neg_hi:[0,1]
    v_pk_add_f32 v[14:15], v[14:15], s[32:33] op_sel_hi:[1,0] neg_lo:[0,1] neg_hi:[0,1]
    v_pk_add_f32 v[16:17], v[16:17], s[32:33] op_sel_hi:[1,0] neg_lo:[0,1] neg_hi:[0,1]
    v_pk_add_f32 v[18:19], v[18:19], s[32:33] op_sel_hi:[1,0] neg_lo:[0,1] neg_hi:[0,1]
    v_pk_add_f32 v[8:9], v[8:9], v[12:13]
    v_pk_fma_f32 v[10:11], v[12:13], v[12:13], v[10:11]
    v_pk_add_f32 v[8:9], v[8:9], v[14:15]
    v_pk_fma_f32 v[10:11], v[14:15], v[14:15], v[10:11]
    v_pk_add_f32 v[8:9], v[8:9], v[16:17]
    v_pk_fma_f32 v[10:11], v[16:17], v[16:17], v[10:11]
    v_pk_add_f32 v[8:9], v[8:9], v[18:19]
    v_pk_fma_f32 v[10:11], v[18:19], v[18:19], v[10:11]
    s_waitcnt vmcnt(5)
    v_lshlrev_b32 v12, 16, v228
    v_and_b32 v13, s42, v228
    v_lshlrev_b32 v14, 16, v229
    v_and_b32 v15, s42, v229
    v_lshlrev_b32 v16, 16, v230
    v_and_b32 v17, s42, v230
    v_lshlrev_b32 v18, 16, v231
    v_and_b32 v19, s42, v231
    v_pk_add_f32 v[12:13], v[12:13], s[32:33] op_sel_hi:[1,0] neg_lo:[0,1] neg_hi:[0,1]
    v_pk_add_f32 v[14:15], v[14:15], s[32:33] op_sel_hi:[1,0] neg_lo:[0,1] neg_hi:[0,1]
    v_pk_add_f32 v[16:17], v[16:17], s[32:33] op_sel_hi:[1,0] neg_lo:[0,1] neg_hi:[0,1]
    v_pk_add_f32 v[18:19], v[18:19], s[32:33] op_sel_hi:[1,0] neg_lo:[0,1] neg_hi:[0,1]
    v_pk_add_f32 v[8:9], v[8:9], v[12:13]
    v_pk_fma_f32 v[10:11], v[12:13], v[12:13], v[10:11]
    v_pk_add_f32 v[8:9], v[8:9], v[14:15]
    v_pk_fma_f32 v[10:11], v[14:15], v[14:15], v[10:11]
    v_pk_add_f32 v[8:9], v[8:9], v[16:17]
    v_pk_fma_f32 v[10:11], v[16:17], v[16:17], v[10:11]
    v_pk_add_f32 v[8:9], v[8:9], v[18:19]
    v_pk_fma_f32 v[10:11], v[18:19], v[18:19], v[10:11]
    s_waitcnt vmcnt(4)
    v_lshlrev_b32 v12, 16, v232
    v_and_b32 v13, s42, v232
    v_lshlrev_b32 v14, 16, v233
    v_and_b32 v15, s42, v233
    v_lshlrev_b32 v16, 16, v234
    v_and_b32 v17, s42, v234
    v_lshlrev_b32 v18, 16, v235
    v_and_b32 v19, s42, v235
    v_pk_add_f32 v[12:13], v[12:13], s[32:33] op_sel_hi:[1,0] neg_lo:[0,1] neg_hi:[0,1]
    v_pk_add_f32 v[14:15], v[14:15], s[32:33] op_sel_hi:[1,0] neg_lo:[0,1] neg_hi:[0,1]
    v_pk_add_f32 v[16:17], v[16:17], s[32:33] op_sel_hi:[1,0] neg_lo:[0,1] neg_hi:[0,1]
    v_pk_add_f32 v[18:19], v[18:19], s[32:33] op_sel_hi:[1,0] neg_lo:[0,1] neg_hi:[0,1]
    v_pk_add_f32 v[8:9], v[8:9], v[12:13]
    v_pk_fma_f32 v[10:11], v[12:13], v[12:13], v[10:11]
    v_pk_add_f32 v[8:9], v[8:9], v[14:15]
    v_pk_fma_f32 v[10:11], v[14:15], v[14:15], v[10:11]
    v_pk_add_f32 v[8:9], v[8:9], v[16:17]
    v_pk_fma_f32 v[10:11], v[16:17], v[16:17], v[10:11]
    v_pk_add_f32 v[8:9], v[8:9], v[18:19]
    v_pk_fma_f32 v[10:11], v[18:19], v[18:19], v[10:11]
    s_waitcnt vmcnt(3)
    v_lshlrev_b32 v12, 16, v236
    v_and_b32 v13, s42, v236
    v_lshlrev_b32 v14, 16, v237
    v_and_b32 v15, s42, v237
    v_lshlrev_b32 v16, 16, v238
    v_and_b32 v17, s42, v238
    v_lshlrev_b32 v18, 16, v239
    v_and_b32 v19, s42, v239
    v_pk_add_f32 v[12:13], v[12:13], s[32:33] op_sel_hi:[1,0] neg_lo:[0,1] neg_hi:[0,1]
    v_pk_add_f32 v[14:15], v[14:15], s[32:33] op_sel_hi:[1,0] neg_lo:[0,1] neg_hi:[0,1]
    v_pk_add_f32 v[16:17], v[16:17], s[32:33] op_sel_hi:[1,0] neg_lo:[0,1] neg_hi:[0,1]
    v_pk_add_f32 v[18:19], v[18:19], s[32:33] op_sel_hi:[1,0] neg_lo:[0,1] neg_hi:[0,1]
    v_pk_add_f32 v[8:9], v[8:9], v[12:13]
    v_pk_fma_f32 v[10:11], v[12:13], v[12:13], v[10:11]
    v_pk_add_f32 v[8:9], v[8:9], v[14:15]
    v_pk_fma_f32 v[10:11], v[14:15], v[14:15], v[10:11]
    v_pk_add_f32 v[8:9], v[8:9], v[16:17]
    v_pk_fma_f32 v[10:11], v[16:17], v[16:17], v[10:11]
    v_pk_add_f32 v[8:9], v[8:9], v[18:19]
    v_pk_fma_f32 v[10:11], v[18:19], v[18:19], v[10:11]
    s_waitcnt vmcnt(2)
    v_lshlrev_b32 v12, 16, v240
    v_and_b32 v13, s42, v240
    v_lshlrev_b32 v14, 16, v241
    v_and_b32 v15, s42, v241
    v_lshlrev_b32 v16, 16, v242
    v_and_b32 v17, s42, v242
    v_lshlrev_b32 v18, 16, v243
    v_and_b32 v19, s42, v243
    v_pk_add_f32 v[12:13], v[12:13], s[32:33] op_sel_hi:[1,0] neg_lo:[0,1] neg_hi:[0,1]
    v_pk_add_f32 v[14:15], v[14:15], s[32:33] op_sel_hi:[1,0] neg_lo:[0,1] neg_hi:[0,1]
    v_pk_add_f32 v[16:17], v[16:17], s[32:33] op_sel_hi:[1,0] neg_lo:[0,1] neg_hi:[0,1]
    v_pk_add_f32 v[18:19], v[18:19], s[32:33] op_sel_hi:[1,0] neg_lo:[0,1] neg_hi:[0,1]
    v_pk_add_f32 v[8:9], v[8:9], v[12:13]
    v_pk_fma_f32 v[10:11], v[12:13], v[12:13], v[10:11]
    v_pk_add_f32 v[8:9], v[8:9], v[14:15]
    v_pk_fma_f32 v[10:11], v[14:15], v[14:15], v[10:11]
    v_pk_add_f32 v[8:9], v[8:9], v[16:17]
    v_pk_fma_f32 v[10:11], v[16:17], v[16:17], v[10:11]
    v_pk_add_f32 v[8:9], v[8:9], v[18:19]
    v_pk_fma_f32 v[10:11], v[18:19], v[18:19], v[10:11]
    s_waitcnt vmcnt(1)
    v_lshlrev_b32 v12, 16, v244
    v_and_b32 v13, s42, v244
    v_lshlrev_b32 v14, 16, v245
    v_and_b32 v15, s42, v245
    v_lshlrev_b32 v16, 16, v246
    v_and_b32 v17, s42, v246
    v_lshlrev_b32 v18, 16, v247
    v_and_b32 v19, s42, v247
    v_pk_add_f32 v[12:13], v[12:13], s[32:33] op_sel_hi:[1,0] neg_lo:[0,1] neg_hi:[0,1]
    v_pk_add_f32 v[14:15], v[14:15], s[32:33] op_sel_hi:[1,0] neg_lo:[0,1] neg_hi:[0,1]
    v_pk_add_f32 v[16:17], v[16:17], s[32:33] op_sel_hi:[1,0] neg_lo:[0,1] neg_hi:[0,1]
    v_pk_add_f32 v[18:19], v[18:19], s[32:33] op_sel_hi:[1,0] neg_lo:[0,1] neg_hi:[0,1]
    v_pk_add_f32 v[8:9], v[8:9], v[12:13]
    v_pk_fma_f32 v[10:11], v[12:13], v[12:13], v[10:11]
    v_pk_add_f32 v[8:9], v[8:9], v[14:15]
    v_pk_fma_f32 v[10:11], v[14:15], v[14:15], v[10:11]
    v_pk_add_f32 v[8:9], v[8:9], v[16:17]
    v_pk_fma_f32 v[10:11], v[16:17], v[16:17], v[10:11]
    v_pk_add_f32 v[8:9], v[8:9], v[18:19]
    v_pk_fma_f32 v[10:11], v[18:19], v[18:19], v[10:11]
    s_waitcnt vmcnt(0)
    v_lshlrev_b32 v12, 16, v248
    v_and_b32 v13, s42, v248
    v_lshlrev_b32 v14, 16, v249
    v_and_b32 v15, s42, v249
    v_lshlrev_b32 v16, 16, v250
    v_and_b32 v17, s42, v250
    v_lshlrev_b32 v18, 16, v251
    v_and_b32 v19, s42, v251
    v_pk_add_f32 v[12:13], v[12:13], s[32:33] op_sel_hi:[1,0] neg_lo:[0,1] neg_hi:[0,1]
    v_pk_add_f32 v[14:15], v[14:15], s[32:33] op_sel_hi:[1,0] neg_lo:[0,1] neg_hi:[0,1]
    v_pk_add_f32 v[16:17], v[16:17], s[32:33] op_sel_hi:[1,0] neg_lo:[0,1] neg_hi:[0,1]
    v_pk_add_f32 v[18:19], v[18:19], s[32:33] op_sel_hi:[1,0] neg_lo:[0,1] neg_hi:[0,1]
    v_pk_add_f32 v[8:9], v[8:9], v[12:13]
    v_pk_fma_f32 v[10:11], v[12:13], v[12:13], v[10:11]
    v_pk_add_f32 v[8:9], v[8:9], v[14:15]
    v_pk_fma_f32 v[10:11], v[14:15], v[14:15], v[10:11]
    v_pk_add_f32 v[8:9], v[8:9], v[16:17]
    v_pk_fma_f32 v[10:11], v[16:17], v[16:17], v[10:11]
    v_pk_add_f32 v[8:9], v[8:9], v[18:19]
    v_pk_fma_f32 v[10:11], v[18:19], v[18:19], v[10:11]
    v_add_f32 v12, v8, v9
    v_add_f32 v14, v10, v11
    s_nop 1
    v_add_f32_dpp v12, v12, v12 row_shr:1 row_mask:0xf bank_mask:0xf
    v_add_f32_dpp v14, v14, v14 row_shr:1 row_mask:0xf bank_mask:0xf
    s_nop 1
    v_add_f32_dpp v12, v12, v12 row_shr:2 row_mask:0xf bank_mask:0xf
    v_add_f32_dpp v14, v14, v14 row_shr:2 row_mask:0xf bank_mask:0xf
    s_nop 1
    v_add_f32_dpp v12, v12, v12 row_shr:4 row_mask:0xf bank_mask:0xf
    v_add_f32_dpp v14, v14, v14 row_shr:4 row_mask:0xf bank_mask:0xf
    s_nop 1
    v_add_f32_dpp v12, v12, v12 row_shr:8 row_mask:0xf bank_mask:0xf
    v_add_f32_dpp v14, v14, v14 row_shr:8 row_mask:0xf bank_mask:0xf
    s_nop 1
    v_add_f32_dpp v12, v12, v12 row_bcast:15 row_mask:0xa bank_mask:0xf
    v_add_f32_dpp v14, v14, v14 row_bcast:15 row_mask:0xa bank_mask:0xf
    s_nop 1
    v_add_f32_dpp v12, v12, v12 row_bcast:31 row_mask:0xc bank_mask:0xf
    v_add_f32_dpp v14, v14, v14 row_bcast:31 row_mask:0xc bank_mask:0xf
    v_mov_b32 v13, s34
    v_mov_b32 v15, s65
    s_lshl_b32 s57, s26, 4
    s_add_u32 s57, s57, 147584
    v_mov_b32 v16, s57
    v_subrev_u32 v17, s43, v2
    v_add_u32 v17, 147584, v17
    s_lshl_b64 exec, 1, 63
    ds_write_b128 v16, v[12:15]
    s_mov_b64 exec, 0xff
    ds_read_b128 v[12:15], v17
    s_waitcnt lgkmcnt(0)
    v_cmp_eq_u32 vcc, s34, v13
    v_cmp_eq_u32 s[58:59], s65, v15
    s_add_u32 s56, s56, 128
    s_nop 0
    s_and_b64 vcc, vcc, s[58:59]
    s_cmp_eq_u64 vcc, exec
    s_cbranch_scc0 L_nopub_5
    s_nop 1
    v_add_f32_dpp v12, v12, v12 row_shr:1 row_mask:0xf bank_mask:0xf
    v_add_f32_dpp v14, v14, v14 row_shr:1 row_mask:0xf bank_mask:0xf
    s_nop 1
    v_add_f32_dpp v12, v12, v12 row_shr:2 row_mask:0xf bank_mask:0xf
    v_add_f32_dpp v14, v14, v14 row_shr:2 row_mask:0xf bank_mask:0xf
    s_nop 1
    v_add_f32_dpp v12, v12, v12 row_shr:4 row_mask:0xf bank_mask:0xf
    v_add_f32_dpp v14, v14, v14 row_shr:4 row_mask:0xf bank_mask:0xf
    s_mov_b64 exec, 0x80
    buffer_store_dwordx4 v[12:15], off, s[12:15], s56 sc1
L_nopub_5:
    s_mov_b64 exec, -1
    s_mov_b32 s35, s28
    v_readlane_b32 s40, v5, 0
    v_readlane_b32 s36, v4, 0
    s_nop 0
    v_mov_b32 v6, s40
    ds_read_b128 v[16:19], v2 offset:0
    s_waitcnt lgkmcnt(0)
    v_lshlrev_b32 v12, 16, v16
    v_and_b32 v13, s42, v16
    v_lshlrev_b32 v14, 16, v17
    v_and_b32 v15, s42, v17
    v_lshlrev_b32 v16, 16, v18
    v_and_b32 v17, s42, v18
    v_lshlrev_b32 v18, 16, v19
    v_and_b32 v19, s42, v19
    v_pk_fma_f32 v[12:13], v[12:13], s[36:37], v[6:7] op_sel_hi:[1,0,0]
    v_pk_fma_f32 v[14:15], v[14:15], s[36:37], v[6:7] op_sel_hi:[1,0,0]
    v_pk_fma_f32 v[16:17], v[16:17], s[36:37], v[6:7] op_sel_hi:[1,0,0]
    v_pk_fma_f32 v[18:19], v[18:19], s[36:37], v[6:7] op_sel_hi:[1,0,0]
    v_cvt_pk_bf16_f32 v12, v12, v13
    v_cvt_pk_bf16_f32 v13, v14, v15
    v_cvt_pk_bf16_f32 v14, v16, v17
    v_cvt_pk_bf16_f32 v15, v18, v19
    buffer_store_dwordx4 v[12:15], v0, s[8:11], s35 offen sc1
    s_nop 1
    ds_read_b128 v[16:19], v2 offset:1024
    s_waitcnt lgkmcnt(0)
    v_lshlrev_b32 v12, 16, v16
    v_and_b32 v13, s42, v16
    v_lshlrev_b32 v14, 16, v17
    v_and_b32 v15, s42, v17
    v_lshlrev_b32 v16, 16, v18
    v_and_b32 v17, s42, v18
    v_lshlrev_b32 v18, 16, v19
    v_and_b32 v19, s42, v19
    v_pk_fma_f32 v[12:13], v[12:13], s[36:37], v[6:7] op_sel_hi:[1,0,0]
    v_pk_fma_f32 v[14:15], v[14:15], s[36:37], v[6:7] op_sel_hi:[1,0,0]
    v_pk_fma_f32 v[16:17], v[16:17], s[36:37], v[6:7] op_sel_hi:[1,0,0]
    v_pk_fma_f32 v[18:19], v[18:19], s[36:37], v[6:7] op_sel_hi:[1,0,0]
    v_cvt_pk_bf16_f32 v12, v12, v13
    v_cvt_pk_bf16_f32 v13, v14, v15
    v_cvt_pk_bf16_f32 v14, v16, v17
    v_cvt_pk_bf16_f32 v15, v18, v19
    buffer_store_dwordx4 v[12:15], v0, s[8:11], s35 offen offset:1024 sc1
    s_nop 1
    s_add_u32 s35, s35, 131072
    v_readlane_b32 s40, v5, 1
    v_readlane_b32 s38, v4, 1
    s_nop 0
    v_mov_b32 v7, s40
    ds_read_b128 v[16:19], v2 offset:2048
    s_waitcnt lgkmcnt(0)
    v_lshlrev_b32 v12, 16, v16
    v_and_b32 v13, s42, v16
    v_lshlrev_b32 v14, 16, v17
    v_and_b32 v15, s42, v17
    v_lshlrev_b32 v16, 16, v18
    v_and_b32 v17, s42, v18
    v_lshlrev_b32 v18, 16, v19
    v_and_b32 v19, s42, v19
    v_pk_fma_f32 v[12:13], v[12:13], s[38:39], v[6:7] op_sel:[0,0,1] op_sel_hi:[1,0,1]
    v_pk_fma_f32 v[14:15], v[14:15], s[38:39], v[6:7] op_sel:[0,0,1] op_sel_hi:[1,0,1]
    v_pk_fma_f32 v[16:17], v[16:17], s[38:39], v[6:7] op_sel:[0,0,1] op_sel_hi:[1,0,1]
    v_pk_fma_f32 v[18:19], v[18:19], s[38:39], v[6:7] op_sel:[0,0,1] op_sel_hi:[1,0,1]
    v_cvt_pk_bf16_f32 v12, v12, v13
    v_cvt_pk_bf16_f32 v13, v14, v15
    v_cvt_pk_bf16_f32 v14, v16, v17
    v_cvt_pk_bf16_f32 v15, v18, v19
    buffer_store_dwordx4 v[12:15], v0, s[8:11], s35 offen sc1
    s_nop 1
    ds_read_b128 v[16:19], v2 offset:3072
    s_waitcnt lgkmcnt(0)
    v_lshlrev_b32 v12, 16, v16
    v_and_b32 v13, s42, v16
    v_lshlrev_b32 v14, 16, v17
    v_and_b32 v15, s42, v17
    v_lshlrev_b32 v16, 16, v18
    v_and_b32 v17, s42, v18
    v_lshlrev_b32 v18, 16, v19
    v_and_b32 v19, s42, v19
    v_pk_fma_f32 v[12:13], v[12:13], s[38:39], v[6:7] op_sel:[0,0,1] op_sel_hi:[1,0,1]
    v_pk_fma_f32 v[14:15], v[14:15], s[38:39], v[6:7] op_sel:[0,0,1] op_sel_hi:[1,0,1]
    v_pk_fma_f32 v[16:17], v[16:17], s[38:39], v[6:7] op_sel:[0,0,1] op_sel_hi:[1,0,1]
    v_pk_fma_f32 v[18:19], v[18:19], s[38:39], v[6:7] op_sel:[0,0,1] op_sel_hi:[1,0,1]
    v_cvt_pk_bf16_f32 v12, v12, v13
    v_cvt_pk_bf16_f32 v13, v14, v15
    v_cvt_pk_bf16_f32 v14, v16, v17
    v_cvt_pk_bf16_f32 v15, v18, v19
    buffer_store_dwordx4 v[12:15], v0, s[8:11], s35 offen offset:1024 sc1
    s_nop 1
    s_add_u32 s35, s35, 131072
    v_readlane_b32 s40, v5, 2
    v_readlane_b32 s36, v4, 2
    s_nop 0
    v_mov_b32 v6, s40
    ds_read_b128 v[16:19], v2 offset:4096
    s_waitcnt lgkmcnt(0)
    v_lshlrev_b32 v12, 16, v16
    v_and_b32 v13, s42, v16
    v_lshlrev_b32 v14, 16, v17
    v_and_b32 v15, s42, v17
    v_lshlrev_b32 v16, 16, v18
    v_and_b32 v17, s42, v18
    v_lshlrev_b32 v18, 16, v19
    v_and_b32 v19, s42, v19
    v_pk_fma_f32 v[12:13], v[12:13], s[36:37], v[6:7] op_sel_hi:[1,0,0]
    v_pk_fma_f32 v[14:15], v[14:15], s[36:37], v[6:7] op_sel_hi:[1,0,0]
    v_pk_fma_f32 v[16:17], v[16:17], s[36:37], v[6:7] op_sel_hi:[1,0,0]
    v_pk_fma_f32 v[18:19], v[18:19], s[36:37], v[6:7] op_sel_hi:[1,0,0]
    v_cvt_pk_bf16_f32 v12, v12, v13
    v_cvt_pk_bf16_f32 v13, v14, v15
    v_cvt_pk_bf16_f32 v14, v16, v17
    v_cvt_pk_bf16_f32 v15, v18, v19
    buffer_store_dwordx4 v[12:15], v0, s[8:11], s35 offen sc1
    s_nop 1
    ds_read_b128 v[16:19], v2 offset:5120
    s_waitcnt lgkmcnt(0)
    v_lshlrev_b32 v12, 16, v16
    v_and_b32 v13, s42, v16
    v_lshlrev_b32 v14, 16, v17
    v_and_b32 v15, s42, v17
    v_lshlrev_b32 v16, 16, v18
    v_and_b32 v17, s42, v18
    v_lshlrev_b32 v18, 16, v19
    v_and_b32 v19, s42, v19
    v_pk_fma_f32 v[12:13], v[12:13], s[36:37], v[6:7] op_sel_hi:[1,0,0]
    v_pk_fma_f32 v[14:15], v[14:15], s[36:37], v[6:7] op_sel_hi:[1,0,0]
    v_pk_fma_f32 v[16:17], v[16:17], s[36:37], v[6:7] op_sel_hi:[1,0,0]
    v_pk_fma_f32 v[18:19], v[18:19], s[36:37], v[6:7] op_sel_hi:[1,0,0]
    v_cvt_pk_bf16_f32 v12, v12, v13
    v_cvt_pk_bf16_f32 v13, v14, v15
    v_cvt_pk_bf16_f32 v14, v16, v17
    v_cvt_pk_bf16_f32 v15, v18, v19
    buffer_store_dwordx4 v[12:15], v0, s[8:11], s35 offen offset:1024 sc1
    s_nop 1
    s_add_u32 s35, s35, 131072
    v_readlane_b32 s40, v5, 3
    v_readlane_b32 s38, v4, 3
    s_nop 0
    v_mov_b32 v7, s40
    ds_read_b128 v[16:19], v2 offset:6144
    s_waitcnt lgkmcnt(0)
    v_lshlrev_b32 v12, 16, v16
    v_and_b32 v13, s42, v16
    v_lshlrev_b32 v14, 16, v17
    v_and_b32 v15, s42, v17
    v_lshlrev_b32 v16, 16, v18
    v_and_b32 v17, s42, v18
    v_lshlrev_b32 v18, 16, v19
    v_and_b32 v19, s42, v19
    v_pk_fma_f32 v[12:13], v[12:13], s[38:39], v[6:7] op_sel:[0,0,1] op_sel_hi:[1,0,1]
    v_pk_fma_f32 v[14:15], v[14:15], s[38:39], v[6:7] op_sel:[0,0,1] op_sel_hi:[1,0,1]
    v_pk_fma_f32 v[16:17], v[16:17], s[38:39], v[6:7] op_sel:[0,0,1] op_sel_hi:[1,0,1]
    v_pk_fma_f32 v[18:19], v[18:19], s[38:39], v[6:7] op_sel:[0,0,1] op_sel_hi:[1,0,1]
    v_cvt_pk_bf16_f32 v12, v12, v13
    v_cvt_pk_bf16_f32 v13, v14, v15
    v_cvt_pk_bf16_f32 v14, v16, v17
    v_cvt_pk_bf16_f32 v15, v18, v19
    buffer_store_dwordx4 v[12:15], v0, s[8:11], s35 offen sc1
    s_nop 1
    ds_read_b128 v[16:19], v2 offset:7168
    s_waitcnt lgkmcnt(0)
    v_lshlrev_b32 v12, 16, v16
    v_and_b32 v13, s42, v16
    v_lshlrev_b32 v14, 16, v17
    v_and_b32 v15, s42, v17
    v_lshlrev_b32 v16, 16, v18
    v_and_b32 v17, s42, v18
    v_lshlrev_b32 v18, 16, v19
    v_and_b32 v19, s42, v19
    v_pk_fma_f32 v[12:13], v[12:13], s[38:39], v[6:7] op_sel:[0,0,1] op_sel_hi:[1,0,1]
    v_pk_fma_f32 v[14:15], v[14:15], s[38:39], v[6:7] op_sel:[0,0,1] op_sel_hi:[1,0,1]
    v_pk_fma_f32 v[16:17], v[16:17], s[38:39], v[6:7] op_sel:[0,0,1] op_sel_hi:[1,0,1]
    v_pk_fma_f32 v[18:19], v[18:19], s[38:39], v[6:7] op_sel:[0,0,1] op_sel_hi:[1,0,1]
    v_cvt_pk_bf16_f32 v12, v12, v13
    v_cvt_pk_bf16_f32 v13, v14, v15
    v_cvt_pk_bf16_f32 v14, v16, v17
    v_cvt_pk_bf16_f32 v15, v18, v19
    buffer_store_dwordx4 v[12:15], v0, s[8:11], s35 offen offset:1024 sc1
    s_nop 1
    s_add_u32 s35, s35, 131072
    v_readlane_b32 s40, v5, 4
    v_readlane_b32 s36, v4, 4
    s_nop 0
    v_mov_b32 v6, s40
    ds_read_b128 v[16:19], v2 offset:8192
    s_waitcnt lgkmcnt(0)
    v_lshlrev_b32 v12, 16, v16
    v_and_b32 v13, s42, v16
    v_lshlrev_b32 v14, 16, v17
    v_and_b32 v15, s42, v17
    v_lshlrev_b32 v16, 16, v18
    v_and_b32 v17, s42, v18
    v_lshlrev_b32 v18, 16, v19
    v_and_b32 v19, s42, v19
    v_pk_fma_f32 v[12:13], v[12:13], s[36:37], v[6:7] op_sel_hi:[1,0,0]
    v_pk_fma_f32 v[14:15], v[14:15], s[36:37], v[6:7] op_sel_hi:[1,0,0]
    v_pk_fma_f32 v[16:17], v[16:17], s[36:37], v[6:7] op_sel_hi:[1,0,0]
    v_pk_fma_f32 v[18:19], v[18:19], s[36:37], v[6:7] op_sel_hi:[1,0,0]
    v_cvt_pk_bf16_f32 v12, v12, v13
    v_cvt_pk_bf16_f32 v13, v14, v15
    v_cvt_pk_bf16_f32 v14, v16, v17
    v_cvt_pk_bf16_f32 v15, v18, v19
    buffer_store_dwordx4 v[12:15], v0, s[8:11], s35 offen sc1
    s_nop 1
    ds_read_b128 v[16:19], v2 offset:9216
    s_waitcnt lgkmcnt(0)
    v_lshlrev_b32 v12, 16, v16
    v_and_b32 v13, s42, v16
    v_lshlrev_b32 v14, 16, v17
    v_and_b32 v15, s42, v17
    v_lshlrev_b32 v16, 16, v18
    v_and_b32 v17, s42, v18
    v_lshlrev_b32 v18, 16, v19
    v_and_b32 v19, s42, v19
    v_pk_fma_f32 v[12:13], v[12:13], s[36:37], v[6:7] op_sel_hi:[1,0,0]
    v_pk_fma_f32 v[14:15], v[14:15], s[36:37], v[6:7] op_sel_hi:[1,0,0]
    v_pk_fma_f32 v[16:17], v[16:17], s[36:37], v[6:7] op_sel_hi:[1,0,0]
    v_pk_fma_f32 v[18:19], v[18:19], s[36:37], v[6:7] op_sel_hi:[1,0,0]
    v_cvt_pk_bf16_f32 v12, v12, v13
    v_cvt_pk_bf16_f32 v13, v14, v15
    v_cvt_pk_bf16_f32 v14, v16, v17
    v_cvt_pk_bf16_f32 v15, v18, v19
    buffer_store_dwordx4 v[12:15], v0, s[8:11], s35 offen offset:1024 sc1
    s_nop 1
    s_add_u32 s35, s35, 131072
    v_readlane_b32 s40, v5, 5
    v_readlane_b32 s38, v4, 5
    s_nop 0
    v_mov_b32 v7, s40
    ds_read_b128 v[16:19], v2 offset:10240
    s_waitcnt lgkmcnt(0)
    v_lshlrev_b32 v12, 16, v16
    v_and_b32 v13, s42, v16
    v_lshlrev_b32 v14, 16, v17
    v_and_b32 v15, s42, v17
    v_lshlrev_b32 v16, 16, v18
    v_and_b32 v17, s42, v18
    v_lshlrev_b32 v18, 16, v19
    v_and_b32 v19, s42, v19
    v_pk_fma_f32 v[12:13], v[12:13], s[38:39], v[6:7] op_sel:[0,0,1] op_sel_hi:[1,0,1]
    v_pk_fma_f32 v[14:15], v[14:15], s[38:39], v[6:7] op_sel:[0,0,1] op_sel_hi:[1,0,1]
    v_pk_fma_f32 v[16:17], v[16:17], s[38:39], v[6:7] op_sel:[0,0,1] op_sel_hi:[1,0,1]
    v_pk_fma_f32 v[18:19], v[18:19], s[38:39], v[6:7] op_sel:[0,0,1] op_sel_hi:[1,0,1]
    v_cvt_pk_bf16_f32 v12, v12, v13
    v_cvt_pk_bf16_f32 v13, v14, v15
    v_cvt_pk_bf16_f32 v14, v16, v17
    v_cvt_pk_bf16_f32 v15, v18, v19
    buffer_store_dwordx4 v[12:15], v0, s[8:11], s35 offen sc1
    s_nop 1
    ds_read_b128 v[16:19], v2 offset:11264
    s_waitcnt lgkmcnt(0)
    v_lshlrev_b32 v12, 16, v16
    v_and_b32 v13, s42, v16
    v_lshlrev_b32 v14, 16, v17
    v_and_b32 v15, s42, v17
    v_lshlrev_b32 v16, 16, v18
    v_and_b32 v17, s42, v18
    v_lshlrev_b32 v18, 16, v19
    v_and_b32 v19, s42, v19
    v_pk_fma_f32 v[12:13], v[12:13], s[38:39], v[6:7] op_sel:[0,0,1] op_sel_hi:[1,0,1]
    v_pk_fma_f32 v[14:15], v[14:15], s[38:39], v[6:7] op_sel:[0,0,1] op_sel_hi:[1,0,1]
    v_pk_fma_f32 v[16:17], v[16:17], s[38:39], v[6:7] op_sel:[0,0,1] op_sel_hi:[1,0,1]
    v_pk_fma_f32 v[18:19], v[18:19], s[38:39], v[6:7] op_sel:[0,0,1] op_sel_hi:[1,0,1]
    v_cvt_pk_bf16_f32 v12, v12, v13
    v_cvt_pk_bf16_f32 v13, v14, v15
    v_cvt_pk_bf16_f32 v14, v16, v17
    v_cvt_pk_bf16_f32 v15, v18, v19
    buffer_store_dwordx4 v[12:15], v0, s[8:11], s35 offen offset:1024 sc1
    s_nop 1
    s_add_u32 s35, s35, 131072
    v_readlane_b32 s40, v5, 6
    v_readlane_b32 s36, v4, 6
    s_nop 0
    v_mov_b32 v6, s40
    ds_read_b128 v[16:19], v2 offset:12288
    s_waitcnt lgkmcnt(0)
    v_lshlrev_b32 v12, 16, v16
    v_and_b32 v13, s42, v16
    v_lshlrev_b32 v14, 16, v17
    v_and_b32 v15, s42, v17
    v_lshlrev_b32 v16, 16, v18
    v_and_b32 v17, s42, v18
    v_lshlrev_b32 v18, 16, v19
    v_and_b32 v19, s42, v19
    v_pk_fma_f32 v[12:13], v[12:13], s[36:37], v[6:7] op_sel_hi:[1,0,0]
    v_pk_fma_f32 v[14:15], v[14:15], s[36:37], v[6:7] op_sel_hi:[1,0,0]
    v_pk_fma_f32 v[16:17], v[16:17], s[36:37], v[6:7] op_sel_hi:[1,0,0]
    v_pk_fma_f32 v[18:19], v[18:19], s[36:37], v[6:7] op_sel_hi:[1,0,0]
    v_cvt_pk_bf16_f32 v12, v12, v13
    v_cvt_pk_bf16_f32 v13, v14, v15
    v_cvt_pk_bf16_f32 v14, v16, v17
    v_cvt_pk_bf16_f32 v15, v18, v19
    buffer_store_dwordx4 v[12:15], v0, s[8:11], s35 offen sc1
    s_nop 1
    ds_read_b128 v[16:19], v2 offset:13312
    s_waitcnt lgkmcnt(0)
    v_lshlrev_b32 v12, 16, v16
    v_and_b32 v13, s42, v16
    v_lshlrev_b32 v14, 16, v17
    v_and_b32 v15, s42, v17
    v_lshlrev_b32 v16, 16, v18
    v_and_b32 v17, s42, v18
    v_lshlrev_b32 v18, 16, v19
    v_and_b32 v19, s42, v19
    v_pk_fma_f32 v[12:13], v[12:13], s[36:37], v[6:7] op_sel_hi:[1,0,0]
    v_pk_fma_f32 v[14:15], v[14:15], s[36:37], v[6:7] op_sel_hi:[1,0,0]
    v_pk_fma_f32 v[16:17], v[16:17], s[36:37], v[6:7] op_sel_hi:[1,0,0]
    v_pk_fma_f32 v[18:19], v[18:19], s[36:37], v[6:7] op_sel_hi:[1,0,0]
    v_cvt_pk_bf16_f32 v12, v12, v13
    v_cvt_pk_bf16_f32 v13, v14, v15
    v_cvt_pk_bf16_f32 v14, v16, v17
    v_cvt_pk_bf16_f32 v15, v18, v19
    buffer_store_dwordx4 v[12:15], v0, s[8:11], s35 offen offset:1024 sc1
    s_nop 1
    s_add_u32 s35, s35, 131072
    v_readlane_b32 s40, v5, 7
    v_readlane_b32 s38, v4, 7
    s_nop 0
    v_mov_b32 v7, s40
    ds_read_b128 v[16:19], v2 offset:14336
    s_waitcnt lgkmcnt(0)
    v_lshlrev_b32 v12, 16, v16
    v_and_b32 v13, s42, v16
    v_lshlrev_b32 v14, 16, v17
    v_and_b32 v15, s42, v17
    v_lshlrev_b32 v16, 16, v18
    v_and_b32 v17, s42, v18
    v_lshlrev_b32 v18, 16, v19
    v_and_b32 v19, s42, v19
    v_pk_fma_f32 v[12:13], v[12:13], s[38:39], v[6:7] op_sel:[0,0,1] op_sel_hi:[1,0,1]
    v_pk_fma_f32 v[14:15], v[14:15], s[38:39], v[6:7] op_sel:[0,0,1] op_sel_hi:[1,0,1]
    v_pk_fma_f32 v[16:17], v[16:17], s[38:39], v[6:7] op_sel:[0,0,1] op_sel_hi:[1,0,1]
    v_pk_fma_f32 v[18:19], v[18:19], s[38:39], v[6:7] op_sel:[0,0,1] op_sel_hi:[1,0,1]
    v_cvt_pk_bf16_f32 v12, v12, v13
    v_cvt_pk_bf16_f32 v13, v14, v15
    v_cvt_pk_bf16_f32 v14, v16, v17
    v_cvt_pk_bf16_f32 v15, v18, v19
    buffer_store_dwordx4 v[12:15], v0, s[8:11], s35 offen sc1
    s_nop 1
    ds_read_b128 v[16:19], v2 offset:15360
    s_waitcnt lgkmcnt(0)
    v_lshlrev_b32 v12, 16, v16
    v_and_b32 v13, s42, v16
    v_lshlrev_b32 v14, 16, v17
    v_and_b32 v15, s42, v17
    v_lshlrev_b32 v16, 16, v18
    v_and_b32 v17, s42, v18
    v_lshlrev_b32 v18, 16, v19
    v_and_b32 v19, s42, v19
    v_pk_fma_f32 v[12:13], v[12:13], s[38:39], v[6:7] op_sel:[0,0,1] op_sel_hi:[1,0,1]
    v_pk_fma_f32 v[14:15], v[14:15], s[38:39], v[6:7] op_sel:[0,0,1] op_sel_hi:[1,0,1]
    v_pk_fma_f32 v[16:17], v[16:17], s[38:39], v[6:7] op_sel:[0,0,1] op_sel_hi:[1,0,1]
    v_pk_fma_f32 v[18:19], v[18:19], s[38:39], v[6:7] op_sel:[0,0,1] op_sel_hi:[1,0,1]
    v_cvt_pk_bf16_f32 v12, v12, v13
    v_cvt_pk_bf16_f32 v13, v14, v15
    v_cvt_pk_bf16_f32 v14, v16, v17
    v_cvt_pk_bf16_f32 v15, v18, v19
    buffer_store_dwordx4 v[12:15], v0, s[8:11], s35 offen offset:1024 sc1
    s_nop 1
    s_add_u32 s35, s35, 131072
    v_readlane_b32 s40, v5, 8
    v_readlane_b32 s36, v4, 8
    s_nop 0
    v_mov_b32 v6, s40
    ds_read_b128 v[16:19], v2 offset:16384
    s_waitcnt lgkmcnt(0)
    v_lshlrev_b32 v12, 16, v16
    v_and_b32 v13, s42, v16
    v_lshlrev_b32 v14, 16, v17
    v_and_b32 v15, s42, v17
    v_lshlrev_b32 v16, 16, v18
    v_and_b32 v17, s42, v18
    v_lshlrev_b32 v18, 16, v19
    v_and_b32 v19, s42, v19
    v_pk_fma_f32 v[12:13], v[12:13], s[36:37], v[6:7] op_sel_hi:[1,0,0]
    v_pk_fma_f32 v[14:15], v[14:15], s[36:37], v[6:7] op_sel_hi:[1,0,0]
    v_pk_fma_f32 v[16:17], v[16:17], s[36:37], v[6:7] op_sel_hi:[1,0,0]
    v_pk_fma_f32 v[18:19], v[18:19], s[36:37], v[6:7] op_sel_hi:[1,0,0]
    v_cvt_pk_bf16_f32 v12, v12, v13
    v_cvt_pk_bf16_f32 v13, v14, v15
    v_cvt_pk_bf16_f32 v14, v16, v17
    v_cvt_pk_bf16_f32 v15, v18, v19
    buffer_store_dwordx4 v[12:15], v0, s[8:11], s35 offen sc1
    s_nop 1
    ds_read_b128 v[16:19], v2 offset:17408
    s_waitcnt lgkmcnt(0)
    v_lshlrev_b32 v12, 16, v16
    v_and_b32 v13, s42, v16
    v_lshlrev_b32 v14, 16, v17
    v_and_b32 v15, s42, v17
    v_lshlrev_b32 v16, 16, v18
    v_and_b32 v17, s42, v18
    v_lshlrev_b32 v18, 16, v19
    v_and_b32 v19, s42, v19
    v_pk_fma_f32 v[12:13], v[12:13], s[36:37], v[6:7] op_sel_hi:[1,0,0]
    v_pk_fma_f32 v[14:15], v[14:15], s[36:37], v[6:7] op_sel_hi:[1,0,0]
    v_pk_fma_f32 v[16:17], v[16:17], s[36:37], v[6:7] op_sel_hi:[1,0,0]
    v_pk_fma_f32 v[18:19], v[18:19], s[36:37], v[6:7] op_sel_hi:[1,0,0]
    v_cvt_pk_bf16_f32 v12, v12, v13
    v_cvt_pk_bf16_f32 v13, v14, v15
    v_cvt_pk_bf16_f32 v14, v16, v17
    v_cvt_pk_bf16_f32 v15, v18, v19
    buffer_store_dwordx4 v[12:15], v0, s[8:11], s35 offen offset:1024 sc1
    s_nop 1
    s_add_u32 s35, s35, 131072
    v_readlane_b32 s40, v5, 9
    v_readlane_b32 s38, v4, 9
    s_nop 0
    v_mov_b32 v7, s40
    v_lshlrev_b32 v12, 16, v20
    v_and_b32 v13, s42, v20
    v_lshlrev_b32 v14, 16, v21
    v_and_b32 v15, s42, v21
    v_lshlrev_b32 v16, 16, v22
    v_and_b32 v17, s42, v22
    v_lshlrev_b32 v18, 16, v23
    v_and_b32 v19, s42, v23
    v_pk_fma_f32 v[12:13], v[12:13], s[38:39], v[6:7] op_sel:[0,0,1] op_sel_hi:[1,0,1]
    v_pk_fma_f32 v[14:15], v[14:15], s[38:39], v[6:7] op_sel:[0,0,1] op_sel_hi:[1,0,1]
    v_pk_fma_f32 v[16:17], v[16:17], s[38:39], v[6:7] op_sel:[0,0,1] op_sel_hi:[1,0,1]
    v_pk_fma_f32 v[18:19], v[18:19], s[38:39], v[6:7] op_sel:[0,0,1] op_sel_hi:[1,0,1]
    v_cvt_pk_bf16_f32 v20, v12, v13
    v_cvt_pk_bf16_f32 v21, v14, v15
    v_cvt_pk_bf16_f32 v22, v16, v17
    v_cvt_pk_bf16_f32 v23, v18, v19
    buffer_store_dwordx4 v[20:23], v0, s[8:11], s35 offen sc1
    v_lshlrev_b32 v12, 16, v24
    v_and_b32 v13, s42, v24
    v_lshlrev_b32 v14, 16, v25
    v_and_b32 v15, s42, v25
    v_lshlrev_b32 v16, 16, v26
    v_and_b32 v17, s42, v26
    v_lshlrev_b32 v18, 16, v27
    v_and_b32 v19, s42, v27
    v_pk_fma_f32 v[12:13], v[12:13], s[38:39], v[6:7] op_sel:[0,0,1] op_sel_hi:[1,0,1]
    v_pk_fma_f32 v[14:15], v[14:15], s[38:39], v[6:7] op_sel:[0,0,1] op_sel_hi:[1,0,1]
    v_pk_fma_f32 v[16:17], v[16:17], s[38:39], v[6:7] op_sel:[0,0,1] op_sel_hi:[1,0,1]
    v_pk_fma_f32 v[18:19], v[18:19], s[38:39], v[6:7] op_sel:[0,0,1] op_sel_hi:[1,0,1]
    v_cvt_pk_bf16_f32 v24, v12, v13
    v_cvt_pk_bf16_f32 v25, v14, v15
    v_cvt_pk_bf16_f32 v26, v16, v17
    v_cvt_pk_bf16_f32 v27, v18, v19
    buffer_store_dwordx4 v[24:27], v0, s[8:11], s35 offen offset:1024 sc1
    s_add_u32 s35, s35, 131072
    v_readlane_b32 s40, v5, 10
    v_readlane_b32 s36, v4, 10
    s_nop 0
    v_mov_b32 v6, s40
    v_lshlrev_b32 v12, 16, v28
    v_and_b32 v13, s42, v28
    v_lshlrev_b32 v14, 16, v29
    v_and_b32 v15, s42, v29
    v_lshlrev_b32 v16, 16, v30
    v_and_b32 v17, s42, v30
    v_lshlrev_b32 v18, 16, v31
    v_and_b32 v19, s42, v31
    v_pk_fma_f32 v[12:13], v[12:13], s[36:37], v[6:7] op_sel_hi:[1,0,0]
    v_pk_fma_f32 v[14:15], v[14:15], s[36:37], v[6:7] op_sel_hi:[1,0,0]
    v_pk_fma_f32 v[16:17], v[16:17], s[36:37], v[6:7] op_sel_hi:[1,0,0]
    v_pk_fma_f32 v[18:19], v[18:19], s[36:37], v[6:7] op_sel_hi:[1,0,0]
    v_cvt_pk_bf16_f32 v28, v12, v13
    v_cvt_pk_bf16_f32 v29, v14, v15
    v_cvt_pk_bf16_f32 v30, v16, v17
    v_cvt_pk_bf16_f32 v31, v18, v19
    buffer_store_dwordx4 v[28:31], v0, s[8:11], s35 offen sc1
    s_add_u32 s55, s55, 128
    s_mov_b64 exec, 0xff
    v_subrev_u32 v16, s43, v2
    buffer_load_dwordx4 v[8:11], v16, s[12:15], s55 offen sc1
    s_mov_b64 exec, -1
    v_lshlrev_b32 v12, 16, v32
    v_and_b32 v13, s42, v32
    v_lshlrev_b32 v14, 16, v33
    v_and_b32 v15, s42, v33
    v_lshlrev_b32 v16, 16, v34
    v_and_b32 v17, s42, v34
    v_lshlrev_b32 v18, 16, v35
    v_and_b32 v19, s42, v35
    v_pk_fma_f32 v[12:13], v[12:13], s[36:37], v[6:7] op_sel_hi:[1,0,0]
    v_pk_fma_f32 v[14:15], v[14:15], s[36:37], v[6:7] op_sel_hi:[1,0,0]
    v_pk_fma_f32 v[16:17], v[16:17], s[36:37], v[6:7] op_sel_hi:[1,0,0]
    v_pk_fma_f32 v[18:19], v[18:19], s[36:37], v[6:7] op_sel_hi:[1,0,0]
    v_cvt_pk_bf16_f32 v32, v12, v13
    v_cvt_pk_bf16_f32 v33, v14, v15
    v_cvt_pk_bf16_f32 v34, v16, v17
    v_cvt_pk_bf16_f32 v35, v18, v19
    buffer_store_dwordx4 v[32:35], v0, s[8:11], s35 offen offset:1024 sc1
    s_add_u32 s35, s35, 131072
    v_readlane_b32 s40, v5, 11
    v_readlane_b32 s38, v4, 11
    s_nop 0
    v_mov_b32 v7, s40
    v_lshlrev_b32 v12, 16, v36
    v_and_b32 v13, s42, v36
    v_lshlrev_b32 v14, 16, v37
    v_and_b32 v15, s42, v37
    v_lshlrev_b32 v16, 16, v38
    v_and_b32 v17, s42, v38
    v_lshlrev_b32 v18, 16, v39
    v_and_b32 v19, s42, v39
    v_pk_fma_f32 v[12:13], v[12:13], s[38:39], v[6:7] op_sel:[0,0,1] op_sel_hi:[1,0,1]
    v_pk_fma_f32 v[14:15], v[14:15], s[38:39], v[6:7] op_sel:[0,0,1] op_sel_hi:[1,0,1]
    v_pk_fma_f32 v[16:17], v[16:17], s[38:39], v[6:7] op_sel:[0,0,1] op_sel_hi:[1,0,1]
    v_pk_fma_f32 v[18:19], v[18:19], s[38:39], v[6:7] op_sel:[0,0,1] op_sel_hi:[1,0,1]
    v_cvt_pk_bf16_f32 v36, v12, v13
    v_cvt_pk_bf16_f32 v37, v14, v15
    v_cvt_pk_bf16_f32 v38, v16, v17
    v_cvt_pk_bf16_f32 v39, v18, v19
    buffer_store_dwordx4 v[36:39], v0, s[8:11], s35 offen sc1
    v_lshlrev_b32 v12, 16, v40
    v_and_b32 v13, s42, v40
    v_lshlrev_b32 v14, 16, v41
    v_and_b32 v15, s42, v41
    v_lshlrev_b32 v16, 16, v42
    v_and_b32 v17, s42, v42
    v_lshlrev_b32 v18, 16, v43
    v_and_b32 v19, s42, v43
    v_pk_fma_f32 v[12:13], v[12:13], s[38:39], v[6:7] op_sel:[0,0,1] op_sel_hi:[1,0,1]
    v_pk_fma_f32 v[14:15], v[14:15], s[38:39], v[6:7] op_sel:[0,0,1] op_sel_hi:[1,0,1]
    v_pk_fma_f32 v[16:17], v[16:17], s[38:39], v[6:7] op_sel:[0,0,1] op_sel_hi:[1,0,1]
    v_pk_fma_f32 v[18:19], v[18:19], s[38:39], v[6:7] op_sel:[0,0,1] op_sel_hi:[1,0,1]
    v_cvt_pk_bf16_f32 v40, v12, v13
    v_cvt_pk_bf16_f32 v41, v14, v15
    v_cvt_pk_bf16_f32 v42, v16, v17
    v_cvt_pk_bf16_f32 v43, v18, v19
    buffer_store_dwordx4 v[40:43], v0, s[8:11], s35 offen offset:1024 sc1
    s_add_u32 s35, s35, 131072
    v_readlane_b32 s40, v5, 12
    v_readlane_b32 s36, v4, 12
    s_nop 0
    v_mov_b32 v6, s40
    v_lshlrev_b32 v12, 16, v44
    v_and_b32 v13, s42, v44
    v_lshlrev_b32 v14, 16, v45
    v_and_b32 v15, s42, v45
    v_lshlrev_b32 v16, 16, v46
    v_and_b32 v17, s42, v46
    v_lshlrev_b32 v18, 16, v47
    v_and_b32 v19, s42, v47
    v_pk_fma_f32 v[12:13], v[12:13], s[36:37], v[6:7] op_sel_hi:[1,0,0]
    v_pk_fma_f32 v[14:15], v[14:15], s[36:37], v[6:7] op_sel_hi:[1,0,0]
    v_pk_fma_f32 v[16:17], v[16:17], s[36:37], v[6:7] op_sel_hi:[1,0,0]
    v_pk_fma_f32 v[18:19], v[18:19], s[36:37], v[6:7] op_sel_hi:[1,0,0]
    v_cvt_pk_bf16_f32 v44, v12, v13
    v_cvt_pk_bf16_f32 v45, v14, v15
    v_cvt_pk_bf16_f32 v46, v16, v17
    v_cvt_pk_bf16_f32 v47, v18, v19
    buffer_store_dwordx4 v[44:47], v0, s[8:11], s35 offen sc1
    v_lshlrev_b32 v12, 16, v48
    v_and_b32 v13, s42, v48
    v_lshlrev_b32 v14, 16, v49
    v_and_b32 v15, s42, v49
    v_lshlrev_b32 v16, 16, v50
    v_and_b32 v17, s42, v50
    v_lshlrev_b32 v18, 16, v51
    v_and_b32 v19, s42, v51
    v_pk_fma_f32 v[12:13], v[12:13], s[36:37], v[6:7] op_sel_hi:[1,0,0]
    v_pk_fma_f32 v[14:15], v[14:15], s[36:37], v[6:7] op_sel_hi:[1,0,0]
    v_pk_fma_f32 v[16:17], v[16:17], s[36:37], v[6:7] op_sel_hi:[1,0,0]
    v_pk_fma_f32 v[18:19], v[18:19], s[36:37], v[6:7] op_sel_hi:[1,0,0]
    v_cvt_pk_bf16_f32 v48, v12, v13
    v_cvt_pk_bf16_f32 v49, v14, v15
    v_cvt_pk_bf16_f32 v50, v16, v17
    v_cvt_pk_bf16_f32 v51, v18, v19
    buffer_store_dwordx4 v[48:51], v0, s[8:11], s35 offen offset:1024 sc1
    s_add_u32 s35, s35, 131072
    v_readlane_b32 s40, v5, 13
    v_readlane_b32 s38, v4, 13
    s_nop 0
    v_mov_b32 v7, s40
    v_lshlrev_b32 v12, 16, v52
    v_and_b32 v13, s42, v52
    v_lshlrev_b32 v14, 16, v53
    v_and_b32 v15, s42, v53
    v_lshlrev_b32 v16, 16, v54
    v_and_b32 v17, s42, v54
    v_lshlrev_b32 v18, 16, v55
    v_and_b32 v19, s42, v55
    v_pk_fma_f32 v[12:13], v[12:13], s[38:39], v[6:7] op_sel:[0,0,1] op_sel_hi:[1,0,1]
    v_pk_fma_f32 v[14:15], v[14:15], s[38:39], v[6:7] op_sel:[0,0,1] op_sel_hi:[1,0,1]
    v_pk_fma_f32 v[16:17], v[16:17], s[38:39], v[6:7] op_sel:[0,0,1] op_sel_hi:[1,0,1]
    v_pk_fma_f32 v[18:19], v[18:19], s[38:39], v[6:7] op_sel:[0,0,1] op_sel_hi:[1,0,1]
    v_cvt_pk_bf16_f32 v52, v12, v13
    v_cvt_pk_bf16_f32 v53, v14, v15
    v_cvt_pk_bf16_f32 v54, v16, v17
    v_cvt_pk_bf16_f32 v55, v18, v19
    buffer_store_dwordx4 v[52:55], v0, s[8:11], s35 offen sc1
    v_lshlrev_b32 v12, 16, v56
    v_and_b32 v13, s42, v56
    v_lshlrev_b32 v14, 16, v57
    v_and_b32 v15, s42, v57
    v_lshlrev_b32 v16, 16, v58
    v_and_b32 v17, s42, v58
    v_lshlrev_b32 v18, 16, v59
    v_and_b32 v19, s42, v59
    v_pk_fma_f32 v[12:13], v[12:13], s[38:39], v[6:7] op_sel:[0,0,1] op_sel_hi:[1,0,1]
    v_pk_fma_f32 v[14:15], v[14:15], s[38:39], v[6:7] op_sel:[0,0,1] op_sel_hi:[1,0,1]
    v_pk_fma_f32 v[16:17], v[16:17], s[38:39], v[6:7] op_sel:[0,0,1] op_sel_hi:[1,0,1]
    v_pk_fma_f32 v[18:19], v[18:19], s[38:39], v[6:7] op_sel:[0,0,1] op_sel_hi:[1,0,1]
    v_cvt_pk_bf16_f32 v56, v12, v13
    v_cvt_pk_bf16_f32 v57, v14, v15
    v_cvt_pk_bf16_f32 v58, v16, v17
    v_cvt_pk_bf16_f32 v59, v18, v19
    buffer_store_dwordx4 v[56:59], v0, s[8:11], s35 offen offset:1024 sc1
    s_add_u32 s35, s35, 131072
    v_readlane_b32 s40, v5, 14
    v_readlane_b32 s36, v4, 14
    s_nop 0
    v_mov_b32 v6, s40
    v_lshlrev_b32 v12, 16, v60
    v_and_b32 v13, s42, v60
    v_lshlrev_b32 v14, 16, v61
    v_and_b32 v15, s42, v61
    v_lshlrev_b32 v16, 16, v62
    v_and_b32 v17, s42, v62
    v_lshlrev_b32 v18, 16, v63
    v_and_b32 v19, s42, v63
    v_pk_fma_f32 v[12:13], v[12:13], s[36:37], v[6:7] op_sel_hi:[1,0,0]
    v_pk_fma_f32 v[14:15], v[14:15], s[36:37], v[6:7] op_sel_hi:[1,0,0]
    v_pk_fma_f32 v[16:17], v[16:17], s[36:37], v[6:7] op_sel_hi:[1,0,0]
    v_pk_fma_f32 v[18:19], v[18:19], s[36:37], v[6:7] op_sel_hi:[1,0,0]
    v_cvt_pk_bf16_f32 v60, v12, v13
    v_cvt_pk_bf16_f32 v61, v14, v15
    v_cvt_pk_bf16_f32 v62, v16, v17
    v_cvt_pk_bf16_f32 v63, v18, v19
    buffer_store_dwordx4 v[60:63], v0, s[8:11], s35 offen sc1
    v_lshlrev_b32 v12, 16, v64
    v_and_b32 v13, s42, v64
    v_lshlrev_b32 v14, 16, v65
    v_and_b32 v15, s42, v65
    v_lshlrev_b32 v16, 16, v66
    v_and_b32 v17, s42, v66
    v_lshlrev_b32 v18, 16, v67
    v_and_b32 v19, s42, v67
    v_pk_fma_f32 v[12:13], v[12:13], s[36:37], v[6:7] op_sel_hi:[1,0,0]
    v_pk_fma_f32 v[14:15], v[14:15], s[36:37], v[6:7] op_sel_hi:[1,0,0]
    v_pk_fma_f32 v[16:17], v[16:17], s[36:37], v[6:7] op_sel_hi:[1,0,0]
    v_pk_fma_f32 v[18:19], v[18:19], s[36:37], v[6:7] op_sel_hi:[1,0,0]
    v_cvt_pk_bf16_f32 v64, v12, v13
    v_cvt_pk_bf16_f32 v65, v14, v15
    v_cvt_pk_bf16_f32 v66, v16, v17
    v_cvt_pk_bf16_f32 v67, v18, v19
    buffer_store_dwordx4 v[64:67], v0, s[8:11], s35 offen offset:1024 sc1
    s_add_u32 s35, s35, 131072
    v_readlane_b32 s40, v5, 15
    v_readlane_b32 s38, v4, 15
    s_nop 0
    v_mov_b32 v7, s40
    v_lshlrev_b32 v12, 16, v68
    v_and_b32 v13, s42, v68
    v_lshlrev_b32 v14, 16, v69
    v_and_b32 v15, s42, v69
    v_lshlrev_b32 v16, 16, v70
    v_and_b32 v17, s42, v70
    v_lshlrev_b32 v18, 16, v71
    v_and_b32 v19, s42, v71
    v_pk_fma_f32 v[12:13], v[12:13], s[38:39], v[6:7] op_sel:[0,0,1] op_sel_hi:[1,0,1]
    v_pk_fma_f32 v[14:15], v[14:15], s[38:39], v[6:7] op_sel:[0,0,1] op_sel_hi:[1,0,1]
    v_pk_fma_f32 v[16:17], v[16:17], s[38:39], v[6:7] op_sel:[0,0,1] op_sel_hi:[1,0,1]
    v_pk_fma_f32 v[18:19], v[18:19], s[38:39], v[6:7] op_sel:[0,0,1] op_sel_hi:[1,0,1]
    v_cvt_pk_bf16_f32 v68, v12, v13
    v_cvt_pk_bf16_f32 v69, v14, v15
    v_cvt_pk_bf16_f32 v70, v16, v17
    v_cvt_pk_bf16_f32 v71, v18, v19
    buffer_store_dwordx4 v[68:71], v0, s[8:11], s35 offen sc1
    v_lshlrev_b32 v12, 16, v72
    v_and_b32 v13, s42, v72
    v_lshlrev_b32 v14, 16, v73
    v_and_b32 v15, s42, v73
    v_lshlrev_b32 v16, 16, v74
    v_and_b32 v17, s42, v74
    v_lshlrev_b32 v18, 16, v75
    v_and_b32 v19, s42, v75
    v_pk_fma_f32 v[12:13], v[12:13], s[38:39], v[6:7] op_sel:[0,0,1] op_sel_hi:[1,0,1]
    v_pk_fma_f32 v[14:15], v[14:15], s[38:39], v[6:7] op_sel:[0,0,1] op_sel_hi:[1,0,1]
    v_pk_fma_f32 v[16:17], v[16:17], s[38:39], v[6:7] op_sel:[0,0,1] op_sel_hi:[1,0,1]
    v_pk_fma_f32 v[18:19], v[18:19], s[38:39], v[6:7] op_sel:[0,0,1] op_sel_hi:[1,0,1]
    v_cvt_pk_bf16_f32 v72, v12, v13
    v_cvt_pk_bf16_f32 v73, v14, v15
    v_cvt_pk_bf16_f32 v74, v16, v17
    v_cvt_pk_bf16_f32 v75, v18, v19
    buffer_store_dwordx4 v[72:75], v0, s[8:11], s35 offen offset:1024 sc1
    s_add_u32 s35, s35, 131072
    v_readlane_b32 s40, v5, 16
    v_readlane_b32 s36, v4, 16
    s_nop 0
    v_mov_b32 v6, s40
    v_lshlrev_b32 v12, 16, v76
    v_and_b32 v13, s42, v76
    v_lshlrev_b32 v14, 16, v77
    v_and_b32 v15, s42, v77
    v_lshlrev_b32 v16, 16, v78
    v_and_b32 v17, s42, v78
    v_lshlrev_b32 v18, 16, v79
    v_and_b32 v19, s42, v79
    v_pk_fma_f32 v[12:13], v[12:13], s[36:37], v[6:7] op_sel_hi:[1,0,0]
    v_pk_fma_f32 v[14:15], v[14:15], s[36:37], v[6:7] op_sel_hi:[1,0,0]
    v_pk_fma_f32 v[16:17], v[16:17], s[36:37], v[6:7] op_sel_hi:[1,0,0]
    v_pk_fma_f32 v[18:19], v[18:19], s[36:37], v[6:7] op_sel_hi:[1,0,0]
    v_cvt_pk_bf16_f32 v76, v12, v13
    v_cvt_pk_bf16_f32 v77, v14, v15
    v_cvt_pk_bf16_f32 v78, v16, v17
    v_cvt_pk_bf16_f32 v79, v18, v19
    buffer_store_dwordx4 v[76:79], v0, s[8:11], s35 offen sc1
    v_lshlrev_b32 v12, 16, v80
    v_and_b32 v13, s42, v80
    v_lshlrev_b32 v14, 16, v81
    v_and_b32 v15, s42, v81
    v_lshlrev_b32 v16, 16, v82
    v_and_b32 v17, s42, v82
    v_lshlrev_b32 v18, 16, v83
    v_and_b32 v19, s42, v83
    v_pk_fma_f32 v[12:13], v[12:13], s[36:37], v[6:7] op_sel_hi:[1,0,0]
    v_pk_fma_f32 v[14:15], v[14:15], s[36:37], v[6:7] op_sel_hi:[1,0,0]
    v_pk_fma_f32 v[16:17], v[16:17], s[36:37], v[6:7] op_sel_hi:[1,0,0]
    v_pk_fma_f32 v[18:19], v[18:19], s[36:37], v[6:7] op_sel_hi:[1,0,0]
    v_cvt_pk_bf16_f32 v80, v12, v13
    v_cvt_pk_bf16_f32 v81, v14, v15
    v_cvt_pk_bf16_f32 v82, v16, v17
    v_cvt_pk_bf16_f32 v83, v18, v19
    buffer_store_dwordx4 v[80:83], v0, s[8:11], s35 offen offset:1024 sc1
    s_add_u32 s35, s35, 131072
    v_readlane_b32 s40, v5, 17
    v_readlane_b32 s38, v4, 17
    s_nop 0
    v_mov_b32 v7, s40
    v_lshlrev_b32 v12, 16, v84
    v_and_b32 v13, s42, v84
    v_lshlrev_b32 v14, 16, v85
    v_and_b32 v15, s42, v85
    v_lshlrev_b32 v16, 16, v86
    v_and_b32 v17, s42, v86
    v_lshlrev_b32 v18, 16, v87
    v_and_b32 v19, s42, v87
    v_pk_fma_f32 v[12:13], v[12:13], s[38:39], v[6:7] op_sel:[0,0,1] op_sel_hi:[1,0,1]
    v_pk_fma_f32 v[14:15], v[14:15], s[38:39], v[6:7] op_sel:[0,0,1] op_sel_hi:[1,0,1]
    v_pk_fma_f32 v[16:17], v[16:17], s[38:39], v[6:7] op_sel:[0,0,1] op_sel_hi:[1,0,1]
    v_pk_fma_f32 v[18:19], v[18:19], s[38:39], v[6:7] op_sel:[0,0,1] op_sel_hi:[1,0,1]
    v_cvt_pk_bf16_f32 v84, v12, v13
    v_cvt_pk_bf16_f32 v85, v14, v15
    v_cvt_pk_bf16_f32 v86, v16, v17
    v_cvt_pk_bf16_f32 v87, v18, v19
    buffer_store_dwordx4 v[84:87], v0, s[8:11], s35 offen sc1
    v_lshlrev_b32 v12, 16, v88
    v_and_b32 v13, s42, v88
    v_lshlrev_b32 v14, 16, v89
    v_and_b32 v15, s42, v89
    v_lshlrev_b32 v16, 16, v90
    v_and_b32 v17, s42, v90
    v_lshlrev_b32 v18, 16, v91
    v_and_b32 v19, s42, v91
    v_pk_fma_f32 v[12:13], v[12:13], s[38:39], v[6:7] op_sel:[0,0,1] op_sel_hi:[1,0,1]
    v_pk_fma_f32 v[14:15], v[14:15], s[38:39], v[6:7] op_sel:[0,0,1] op_sel_hi:[1,0,1]
    v_pk_fma_f32 v[16:17], v[16:17], s[38:39], v[6:7] op_sel:[0,0,1] op_sel_hi:[1,0,1]
    v_pk_fma_f32 v[18:19], v[18:19], s[38:39], v[6:7] op_sel:[0,0,1] op_sel_hi:[1,0,1]
    v_cvt_pk_bf16_f32 v88, v12, v13
    v_cvt_pk_bf16_f32 v89, v14, v15
    v_cvt_pk_bf16_f32 v90, v16, v17
    v_cvt_pk_bf16_f32 v91, v18, v19
    buffer_store_dwordx4 v[88:91], v0, s[8:11], s35 offen offset:1024 sc1
    s_waitcnt vmcnt(15)
    s_mov_b32 s57, 20000
    s_mov_b64 exec, 0xff
L_chk_6:
    v_cmp_eq_u32 vcc, s34, v9
    v_cmp_eq_u32 s[58:59], s65, v11
    s_nop 1
    s_and_b64 vcc, vcc, s[58:59]
    s_cmp_eq_u64 vcc, exec
    s_cbranch_scc1 L_ok_7
    s_sub_u32 s57, s57, 1
    s_cmp_eq_u32 s57, 0
    s_cbranch_scc1 L_ok_7
    s_sleep 8
    v_subrev_u32 v16, s43, v2
    buffer_load_dwordx4 v[8:11], v16, s[12:15], s55 offen sc1
    s_waitcnt vmcnt(0)
    s_branch L_chk_6
L_ok_7:
    s_nop 1
    v_add_f32_dpp v8, v8, v8 row_shr:1 row_mask:0xf bank_mask:0xf
    v_add_f32_dpp v10, v10, v10 row_shr:1 row_mask:0xf bank_mask:0xf
    s_nop 1
    v_add_f32_dpp v8, v8, v8 row_shr:2 row_mask:0xf bank_mask:0xf
    v_add_f32_dpp v10, v10, v10 row_shr:2 row_mask:0xf bank_mask:0xf
    s_nop 1
    v_add_f32_dpp v8, v8, v8 row_shr:4 row_mask:0xf bank_mask:0xf
    v_add_f32_dpp v10, v10, v10 row_shr:4 row_mask:0xf bank_mask:0xf
    s_mov_b64 exec, -1
    s_nop 1
    v_readlane_b32 s58, v8, 7
    v_readlane_b32 s59, v10, 7
    s_mov_b32 s57, 0x35638e39
    v_mov_b32 v12, s58
    v_mov_b32 v13, s59
    v_mul_f32 v12, s57, v12
    v_mul_f32 v13, s57, v13
    v_fma_f32 v13, -v12, v12, v13
    v_max_f32 v13, 0, v13
    v_add_f32 v13, 0x3727c5ac, v13
    v_rsq_f32 v13, v13
    v_add_f32 v12, s32, v12
    v_lshlrev_b32 v14, 16, v3
    v_and_b32 v15, s42, v3
    v_mul_f32 v4, v14, v13
    v_fma_f32 v5, -v12, v4, v15
    s_mov_b32 s35, s29
    v_readlane_b32 s40, v5, 0
    v_readlane_b32 s36, v4, 0
    s_nop 0
    v_mov_b32 v6, s40
    v_lshlrev_b32 v12, 16, v92
    v_and_b32 v13, s42, v92
    v_lshlrev_b32 v14, 16, v93
    v_and_b32 v15, s42, v93
    v_lshlrev_b32 v16, 16, v94
    v_and_b32 v17, s42, v94
    v_lshlrev_b32 v18, 16, v95
    v_and_b32 v19, s42, v95
    v_pk_fma_f32 v[12:13], v[12:13], s[36:37], v[6:7] op_sel_hi:[1,0,0]
    v_pk_fma_f32 v[14:15], v[14:15], s[36:37], v[6:7] op_sel_hi:[1,0,0]
    v_pk_fma_f32 v[16:17], v[16:17], s[36:37], v[6:7] op_sel_hi:[1,0,0]
    v_pk_fma_f32 v[18:19], v[18:19], s[36:37], v[6:7] op_sel_hi:[1,0,0]
    v_cvt_pk_bf16_f32 v92, v12, v13
    v_cvt_pk_bf16_f32 v93, v14, v15
    v_cvt_pk_bf16_f32 v94, v16, v17
    v_cvt_pk_bf16_f32 v95, v18, v19
    buffer_store_dwordx4 v[92:95], v0, s[8:11], s35 offen sc1
    v_lshlrev_b32 v12, 16, v96
    v_and_b32 v13, s42, v96
    v_lshlrev_b32 v14, 16, v97
    v_and_b32 v15, s42, v97
    v_lshlrev_b32 v16, 16, v98
    v_and_b32 v17, s42, v98
    v_lshlrev_b32 v18, 16, v99
    v_and_b32 v19, s42, v99
    v_pk_fma_f32 v[12:13], v[12:13], s[36:37], v[6:7] op_sel_hi:[1,0,0]
    v_pk_fma_f32 v[14:15], v[14:15], s[36:37], v[6:7] op_sel_hi:[1,0,0]
    v_pk_fma_f32 v[16:17], v[16:17], s[36:37], v[6:7] op_sel_hi:[1,0,0]
    v_pk_fma_f32 v[18:19], v[18:19], s[36:37], v[6:7] op_sel_hi:[1,0,0]
    v_cvt_pk_bf16_f32 v96, v12, v13
    v_cvt_pk_bf16_f32 v97, v14, v15
    v_cvt_pk_bf16_f32 v98, v16, v17
    v_cvt_pk_bf16_f32 v99, v18, v19
    buffer_store_dwordx4 v[96:99], v0, s[8:11], s35 offen offset:1024 sc1
    s_add_u32 s35, s35, 131072
    v_readlane_b32 s40, v5, 1
    v_readlane_b32 s38, v4, 1
    s_nop 0
    v_mov_b32 v7, s40
    v_lshlrev_b32 v12, 16, v100
    v_and_b32 v13, s42, v100
    v_lshlrev_b32 v14, 16, v101
    v_and_b32 v15, s42, v101
    v_lshlrev_b32 v16, 16, v102
    v_and_b32 v17, s42, v102
    v_lshlrev_b32 v18, 16, v103
    v_and_b32 v19, s42, v103
    v_pk_fma_f32 v[12:13], v[12:13], s[38:39], v[6:7] op_sel:[0,0,1] op_sel_hi:[1,0,1]
    v_pk_fma_f32 v[14:15], v[14:15], s[38:39], v[6:7] op_sel:[0,0,1] op_sel_hi:[1,0,1]
    v_pk_fma_f32 v[16:17], v[16:17], s[38:39], v[6:7] op_sel:[0,0,1] op_sel_hi:[1,0,1]
    v_pk_fma_f32 v[18:19], v[18:19], s[38:39], v[6:7] op_sel:[0,0,1] op_sel_hi:[1,0,1]
    v_cvt_pk_bf16_f32 v100, v12, v13
    v_cvt_pk_bf16_f32 v101, v14, v15
    v_cvt_pk_bf16_f32 v102, v16, v17
    v_cvt_pk_bf16_f32 v103, v18, v19
    buffer_store_dwordx4 v[100:103], v0, s[8:11], s35 offen sc1
    v_lshlrev_b32 v12, 16, v104
    v_and_b32 v13, s42, v104
    v_lshlrev_b32 v14, 16, v105
    v_and_b32 v15, s42, v105
    v_lshlrev_b32 v16, 16, v106
    v_and_b32 v17, s42, v106
    v_lshlrev_b32 v18, 16, v107
    v_and_b32 v19, s42, v107
    v_pk_fma_f32 v[12:13], v[12:13], s[38:39], v[6:7] op_sel:[0,0,1] op_sel_hi:[1,0,1]
    v_pk_fma_f32 v[14:15], v[14:15], s[38:39], v[6:7] op_sel:[0,0,1] op_sel_hi:[1,0,1]
    v_pk_fma_f32 v[16:17], v[16:17], s[38:39], v[6:7] op_sel:[0,0,1] op_sel_hi:[1,0,1]
    v_pk_fma_f32 v[18:19], v[18:19], s[38:39], v[6:7] op_sel:[0,0,1] op_sel_hi:[1,0,1]
    v_cvt_pk_bf16_f32 v104, v12, v13
    v_cvt_pk_bf16_f32 v105, v14, v15
    v_cvt_pk_bf16_f32 v106, v16, v17
    v_cvt_pk_bf16_f32 v107, v18, v19
    buffer_store_dwordx4 v[104:107], v0, s[8:11], s35 offen offset:1024 sc1
    s_add_u32 s35, s35, 131072
    v_readlane_b32 s40, v5, 2
    v_readlane_b32 s36, v4, 2
    s_nop 0
    v_mov_b32 v6, s40
    v_lshlrev_b32 v12, 16, v108
    v_and_b32 v13, s42, v108
    v_lshlrev_b32 v14, 16, v109
    v_and_b32 v15, s42, v109
    v_lshlrev_b32 v16, 16, v110
    v_and_b32 v17, s42, v110
    v_lshlrev_b32 v18, 16, v111
    v_and_b32 v19, s42, v111
    v_pk_fma_f32 v[12:13], v[12:13], s[36:37], v[6:7] op_sel_hi:[1,0,0]
    v_pk_fma_f32 v[14:15], v[14:15], s[36:37], v[6:7] op_sel_hi:[1,0,0]
    v_pk_fma_f32 v[16:17], v[16:17], s[36:37], v[6:7] op_sel_hi:[1,0,0]
    v_pk_fma_f32 v[18:19], v[18:19], s[36:37], v[6:7] op_sel_hi:[1,0,0]
    v_cvt_pk_bf16_f32 v108, v12, v13
    v_cvt_pk_bf16_f32 v109, v14, v15
    v_cvt_pk_bf16_f32 v110, v16, v17
    v_cvt_pk_bf16_f32 v111, v18, v19
    buffer_store_dwordx4 v[108:111], v0, s[8:11], s35 offen sc1
    v_lshlrev_b32 v12, 16, v112
    v_and_b32 v13, s42, v112
    v_lshlrev_b32 v14, 16, v113
    v_and_b32 v15, s42, v113
    v_lshlrev_b32 v16, 16, v114
    v_and_b32 v17, s42, v114
    v_lshlrev_b32 v18, 16, v115
    v_and_b32 v19, s42, v115
    v_pk_fma_f32 v[12:13], v[12:13], s[36:37], v[6:7] op_sel_hi:[1,0,0]
    v_pk_fma_f32 v[14:15], v[14:15], s[36:37], v[6:7] op_sel_hi:[1,0,0]
    v_pk_fma_f32 v[16:17], v[16:17], s[36:37], v[6:7] op_sel_hi:[1,0,0]
    v_pk_fma_f32 v[18:19], v[18:19], s[36:37], v[6:7] op_sel_hi:[1,0,0]
    v_cvt_pk_bf16_f32 v112, v12, v13
    v_cvt_pk_bf16_f32 v113, v14, v15
    v_cvt_pk_bf16_f32 v114, v16, v17
    v_cvt_pk_bf16_f32 v115, v18, v19
    buffer_store_dwordx4 v[112:115], v0, s[8:11], s35 offen offset:1024 sc1
    s_add_u32 s35, s35, 131072
    v_readlane_b32 s40, v5, 3
    v_readlane_b32 s38, v4, 3
    s_nop 0
    v_mov_b32 v7, s40
    v_lshlrev_b32 v12, 16, v116
    v_and_b32 v13, s42, v116
    v_lshlrev_b32 v14, 16, v117
    v_and_b32 v15, s42, v117
    v_lshlrev_b32 v16, 16, v118
    v_and_b32 v17, s42, v118
    v_lshlrev_b32 v18, 16, v119
    v_and_b32 v19, s42, v119
    v_pk_fma_f32 v[12:13], v[12:13], s[38:39], v[6:7] op_sel:[0,0,1] op_sel_hi:[1,0,1]
    v_pk_fma_f32 v[14:15], v[14:15], s[38:39], v[6:7] op_sel:[0,0,1] op_sel_hi:[1,0,1]
    v_pk_fma_f32 v[16:17], v[16:17], s[38:39], v[6:7] op_sel:[0,0,1] op_sel_hi:[1,0,1]
    v_pk_fma_f32 v[18:19], v[18:19], s[38:39], v[6:7] op_sel:[0,0,1] op_sel_hi:[1,0,1]
    v_cvt_pk_bf16_f32 v116, v12, v13
    v_cvt_pk_bf16_f32 v117, v14, v15
    v_cvt_pk_bf16_f32 v118, v16, v17
    v_cvt_pk_bf16_f32 v119, v18, v19
    buffer_store_dwordx4 v[116:119], v0, s[8:11], s35 offen sc1
    v_lshlrev_b32 v12, 16, v120
    v_and_b32 v13, s42, v120
    v_lshlrev_b32 v14, 16, v121
    v_and_b32 v15, s42, v121
    v_lshlrev_b32 v16, 16, v122
    v_and_b32 v17, s42, v122
    v_lshlrev_b32 v18, 16, v123
    v_and_b32 v19, s42, v123
    v_pk_fma_f32 v[12:13], v[12:13], s[38:39], v[6:7] op_sel:[0,0,1] op_sel_hi:[1,0,1]
    v_pk_fma_f32 v[14:15], v[14:15], s[38:39], v[6:7] op_sel:[0,0,1] op_sel_hi:[1,0,1]
    v_pk_fma_f32 v[16:17], v[16:17], s[38:39], v[6:7] op_sel:[0,0,1] op_sel_hi:[1,0,1]
    v_pk_fma_f32 v[18:19], v[18:19], s[38:39], v[6:7] op_sel:[0,0,1] op_sel_hi:[1,0,1]
    v_cvt_pk_bf16_f32 v120, v12, v13
    v_cvt_pk_bf16_f32 v121, v14, v15
    v_cvt_pk_bf16_f32 v122, v16, v17
    v_cvt_pk_bf16_f32 v123, v18, v19
    buffer_store_dwordx4 v[120:123], v0, s[8:11], s35 offen offset:1024 sc1
    s_add_u32 s35, s35, 131072
    v_readlane_b32 s40, v5, 4
    v_readlane_b32 s36, v4, 4
    s_nop 0
    v_mov_b32 v6, s40
    v_lshlrev_b32 v12, 16, v124
    v_and_b32 v13, s42, v124
    v_lshlrev_b32 v14, 16, v125
    v_and_b32 v15, s42, v125
    v_lshlrev_b32 v16, 16, v126
    v_and_b32 v17, s42, v126
    v_lshlrev_b32 v18, 16, v127
    v_and_b32 v19, s42, v127
    v_pk_fma_f32 v[12:13], v[12:13], s[36:37], v[6:7] op_sel_hi:[1,0,0]
    v_pk_fma_f32 v[14:15], v[14:15], s[36:37], v[6:7] op_sel_hi:[1,0,0]
    v_pk_fma_f32 v[16:17], v[16:17], s[36:37], v[6:7] op_sel_hi:[1,0,0]
    v_pk_fma_f32 v[18:19], v[18:19], s[36:37], v[6:7] op_sel_hi:[1,0,0]
    v_cvt_pk_bf16_f32 v124, v12, v13
    v_cvt_pk_bf16_f32 v125, v14, v15
    v_cvt_pk_bf16_f32 v126, v16, v17
    v_cvt_pk_bf16_f32 v127, v18, v19
    buffer_store_dwordx4 v[124:127], v0, s[8:11], s35 offen sc1
    v_lshlrev_b32 v12, 16, v128
    v_and_b32 v13, s42, v128
    v_lshlrev_b32 v14, 16, v129
    v_and_b32 v15, s42, v129
    v_lshlrev_b32 v16, 16, v130
    v_and_b32 v17, s42, v130
    v_lshlrev_b32 v18, 16, v131
    v_and_b32 v19, s42, v131
    v_pk_fma_f32 v[12:13], v[12:13], s[36:37], v[6:7] op_sel_hi:[1,0,0]
    v_pk_fma_f32 v[14:15], v[14:15], s[36:37], v[6:7] op_sel_hi:[1,0,0]
    v_pk_fma_f32 v[16:17], v[16:17], s[36:37], v[6:7] op_sel_hi:[1,0,0]
    v_pk_fma_f32 v[18:19], v[18:19], s[36:37], v[6:7] op_sel_hi:[1,0,0]
    v_cvt_pk_bf16_f32 v128, v12, v13
    v_cvt_pk_bf16_f32 v129, v14, v15
    v_cvt_pk_bf16_f32 v130, v16, v17
    v_cvt_pk_bf16_f32 v131, v18, v19
    buffer_store_dwordx4 v[128:131], v0, s[8:11], s35 offen offset:1024 sc1
    s_add_u32 s35, s35, 131072
    v_readlane_b32 s40, v5, 5
    v_readlane_b32 s38, v4, 5
    s_nop 0
    v_mov_b32 v7, s40
    v_lshlrev_b32 v12, 16, v132
    v_and_b32 v13, s42, v132
    v_lshlrev_b32 v14, 16, v133
    v_and_b32 v15, s42, v133
    v_lshlrev_b32 v16, 16, v134
    v_and_b32 v17, s42, v134
    v_lshlrev_b32 v18, 16, v135
    v_and_b32 v19, s42, v135
    v_pk_fma_f32 v[12:13], v[12:13], s[38:39], v[6:7] op_sel:[0,0,1] op_sel_hi:[1,0,1]
    v_pk_fma_f32 v[14:15], v[14:15], s[38:39], v[6:7] op_sel:[0,0,1] op_sel_hi:[1,0,1]
    v_pk_fma_f32 v[16:17], v[16:17], s[38:39], v[6:7] op_sel:[0,0,1] op_sel_hi:[1,0,1]
    v_pk_fma_f32 v[18:19], v[18:19], s[38:39], v[6:7] op_sel:[0,0,1] op_sel_hi:[1,0,1]
    v_cvt_pk_bf16_f32 v132, v12, v13
    v_cvt_pk_bf16_f32 v133, v14, v15
    v_cvt_pk_bf16_f32 v134, v16, v17
    v_cvt_pk_bf16_f32 v135, v18, v19
    buffer_store_dwordx4 v[132:135], v0, s[8:11], s35 offen sc1
    v_lshlrev_b32 v12, 16, v136
    v_and_b32 v13, s42, v136
    v_lshlrev_b32 v14, 16, v137
    v_and_b32 v15, s42, v137
    v_lshlrev_b32 v16, 16, v138
    v_and_b32 v17, s42, v138
    v_lshlrev_b32 v18, 16, v139
    v_and_b32 v19, s42, v139
    v_pk_fma_f32 v[12:13], v[12:13], s[38:39], v[6:7] op_sel:[0,0,1] op_sel_hi:[1,0,1]
    v_pk_fma_f32 v[14:15], v[14:15], s[38:39], v[6:7] op_sel:[0,0,1] op_sel_hi:[1,0,1]
    v_pk_fma_f32 v[16:17], v[16:17], s[38:39], v[6:7] op_sel:[0,0,1] op_sel_hi:[1,0,1]
    v_pk_fma_f32 v[18:19], v[18:19], s[38:39], v[6:7] op_sel:[0,0,1] op_sel_hi:[1,0,1]
    v_cvt_pk_bf16_f32 v136, v12, v13
    v_cvt_pk_bf16_f32 v137, v14, v15
    v_cvt_pk_bf16_f32 v138, v16, v17
    v_cvt_pk_bf16_f32 v139, v18, v19
    buffer_store_dwordx4 v[136:139], v0, s[8:11], s35 offen offset:1024 sc1
    s_add_u32 s35, s35, 131072
    v_readlane_b32 s40, v5, 6
    v_readlane_b32 s36, v4, 6
    s_nop 0
    v_mov_b32 v6, s40
    v_lshlrev_b32 v12, 16, v140
    v_and_b32 v13, s42, v140
    v_lshlrev_b32 v14, 16, v141
    v_and_b32 v15, s42, v141
    v_lshlrev_b32 v16, 16, v142
    v_and_b32 v17, s42, v142
    v_lshlrev_b32 v18, 16, v143
    v_and_b32 v19, s42, v143
    v_pk_fma_f32 v[12:13], v[12:13], s[36:37], v[6:7] op_sel_hi:[1,0,0]
    v_pk_fma_f32 v[14:15], v[14:15], s[36:37], v[6:7] op_sel_hi:[1,0,0]
    v_pk_fma_f32 v[16:17], v[16:17], s[36:37], v[6:7] op_sel_hi:[1,0,0]
    v_pk_fma_f32 v[18:19], v[18:19], s[36:37], v[6:7] op_sel_hi:[1,0,0]
    v_cvt_pk_bf16_f32 v140, v12, v13
    v_cvt_pk_bf16_f32 v141, v14, v15
    v_cvt_pk_bf16_f32 v142, v16, v17
    v_cvt_pk_bf16_f32 v143, v18, v19
    buffer_store_dwordx4 v[140:143], v0, s[8:11], s35 offen sc1
    v_lshlrev_b32 v12, 16, v144
    v_and_b32 v13, s42, v144
    v_lshlrev_b32 v14, 16, v145
    v_and_b32 v15, s42, v145
    v_lshlrev_b32 v16, 16, v146
    v_and_b32 v17, s42, v146
    v_lshlrev_b32 v18, 16, v147
    v_and_b32 v19, s42, v147
    v_pk_fma_f32 v[12:13], v[12:13], s[36:37], v[6:7] op_sel_hi:[1,0,0]
    v_pk_fma_f32 v[14:15], v[14:15], s[36:37], v[6:7] op_sel_hi:[1,0,0]
    v_pk_fma_f32 v[16:17], v[16:17], s[36:37], v[6:7] op_sel_hi:[1,0,0]
    v_pk_fma_f32 v[18:19], v[18:19], s[36:37], v[6:7] op_sel_hi:[1,0,0]
    v_cvt_pk_bf16_f32 v144, v12, v13
    v_cvt_pk_bf16_f32 v145, v14, v15
    v_cvt_pk_bf16_f32 v146, v16, v17
    v_cvt_pk_bf16_f32 v147, v18, v19
    buffer_store_dwordx4 v[144:147], v0, s[8:11], s35 offen offset:1024 sc1
    s_add_u32 s35, s35, 131072
    v_readlane_b32 s40, v5, 7
    v_readlane_b32 s38, v4, 7
    s_nop 0
    v_mov_b32 v7, s40
    v_lshlrev_b32 v12, 16, v148
    v_and_b32 v13, s42, v148
    v_lshlrev_b32 v14, 16, v149
    v_and_b32 v15, s42, v149
    v_lshlrev_b32 v16, 16, v150
    v_and_b32 v17, s42, v150
    v_lshlrev_b32 v18, 16, v151
    v_and_b32 v19, s42, v151
    v_pk_fma_f32 v[12:13], v[12:13], s[38:39], v[6:7] op_sel:[0,0,1] op_sel_hi:[1,0,1]
    v_pk_fma_f32 v[14:15], v[14:15], s[38:39], v[6:7] op_sel:[0,0,1] op_sel_hi:[1,0,1]
    v_pk_fma_f32 v[16:17], v[16:17], s[38:39], v[6:7] op_sel:[0,0,1] op_sel_hi:[1,0,1]
    v_pk_fma_f32 v[18:19], v[18:19], s[38:39], v[6:7] op_sel:[0,0,1] op_sel_hi:[1,0,1]
    v_cvt_pk_bf16_f32 v148, v12, v13
    v_cvt_pk_bf16_f32 v149, v14, v15
    v_cvt_pk_bf16_f32 v150, v16, v17
    v_cvt_pk_bf16_f32 v151, v18, v19
    buffer_store_dwordx4 v[148:151], v0, s[8:11], s35 offen sc1
    v_lshlrev_b32 v12, 16, v152
    v_and_b32 v13, s42, v152
    v_lshlrev_b32 v14, 16, v153
    v_and_b32 v15, s42, v153
    v_lshlrev_b32 v16, 16, v154
    v_and_b32 v17, s42, v154
    v_lshlrev_b32 v18, 16, v155
    v_and_b32 v19, s42, v155
    v_pk_fma_f32 v[12:13], v[12:13], s[38:39], v[6:7] op_sel:[0,0,1] op_sel_hi:[1,0,1]
    v_pk_fma_f32 v[14:15], v[14:15], s[38:39], v[6:7] op_sel:[0,0,1] op_sel_hi:[1,0,1]
    v_pk_fma_f32 v[16:17], v[16:17], s[38:39], v[6:7] op_sel:[0,0,1] op_sel_hi:[1,0,1]
    v_pk_fma_f32 v[18:19], v[18:19], s[38:39], v[6:7] op_sel:[0,0,1] op_sel_hi:[1,0,1]
    v_cvt_pk_bf16_f32 v152, v12, v13
    v_cvt_pk_bf16_f32 v153, v14, v15
    v_cvt_pk_bf16_f32 v154, v16, v17
    v_cvt_pk_bf16_f32 v155, v18, v19
    buffer_store_dwordx4 v[152:155], v0, s[8:11], s35 offen offset:1024 sc1
    s_add_u32 s35, s35, 131072
    v_readlane_b32 s40, v5, 8
    v_readlane_b32 s36, v4, 8
    s_nop 0
    v_mov_b32 v6, s40
    v_lshlrev_b32 v12, 16, v156
    v_and_b32 v13, s42, v156
    v_lshlrev_b32 v14, 16, v157
    v_and_b32 v15, s42, v157
    v_lshlrev_b32 v16, 16, v158
    v_and_b32 v17, s42, v158
    v_lshlrev_b32 v18, 16, v159
    v_and_b32 v19, s42, v159
    v_pk_fma_f32 v[12:13], v[12:13], s[36:37], v[6:7] op_sel_hi:[1,0,0]
    v_pk_fma_f32 v[14:15], v[14:15], s[36:37], v[6:7] op_sel_hi:[1,0,0]
    v_pk_fma_f32 v[16:17], v[16:17], s[36:37], v[6:7] op_sel_hi:[1,0,0]
    v_pk_fma_f32 v[18:19], v[18:19], s[36:37], v[6:7] op_sel_hi:[1,0,0]
    v_cvt_pk_bf16_f32 v156, v12, v13
    v_cvt_pk_bf16_f32 v157, v14, v15
    v_cvt_pk_bf16_f32 v158, v16, v17
    v_cvt_pk_bf16_f32 v159, v18, v19
    buffer_store_dwordx4 v[156:159], v0, s[8:11], s35 offen sc1
    v_lshlrev_b32 v12, 16, v160
    v_and_b32 v13, s42, v160
    v_lshlrev_b32 v14, 16, v161
    v_and_b32 v15, s42, v161
    v_lshlrev_b32 v16, 16, v162
    v_and_b32 v17, s42, v162
    v_lshlrev_b32 v18, 16, v163
    v_and_b32 v19, s42, v163
    v_pk_fma_f32 v[12:13], v[12:13], s[36:37], v[6:7] op_sel_hi:[1,0,0]
    v_pk_fma_f32 v[14:15], v[14:15], s[36:37], v[6:7] op_sel_hi:[1,0,0]
    v_pk_fma_f32 v[16:17], v[16:17], s[36:37], v[6:7] op_sel_hi:[1,0,0]
    v_pk_fma_f32 v[18:19], v[18:19], s[36:37], v[6:7] op_sel_hi:[1,0,0]
    v_cvt_pk_bf16_f32 v160, v12, v13
    v_cvt_pk_bf16_f32 v161, v14, v15
    v_cvt_pk_bf16_f32 v162, v16, v17
    v_cvt_pk_bf16_f32 v163, v18, v19
    buffer_store_dwordx4 v[160:163], v0, s[8:11], s35 offen offset:1024 sc1
    s_add_u32 s35, s35, 131072
    v_readlane_b32 s40, v5, 9
    v_readlane_b32 s38, v4, 9
    s_nop 0
    v_mov_b32 v7, s40
    v_lshlrev_b32 v12, 16, v164
    v_and_b32 v13, s42, v164
    v_lshlrev_b32 v14, 16, v165
    v_and_b32 v15, s42, v165
    v_lshlrev_b32 v16, 16, v166
    v_and_b32 v17, s42, v166
    v_lshlrev_b32 v18, 16, v167
    v_and_b32 v19, s42, v167
    v_pk_fma_f32 v[12:13], v[12:13], s[38:39], v[6:7] op_sel:[0,0,1] op_sel_hi:[1,0,1]
    v_pk_fma_f32 v[14:15], v[14:15], s[38:39], v[6:7] op_sel:[0,0,1] op_sel_hi:[1,0,1]
    v_pk_fma_f32 v[16:17], v[16:17], s[38:39], v[6:7] op_sel:[0,0,1] op_sel_hi:[1,0,1]
    v_pk_fma_f32 v[18:19], v[18:19], s[38:39], v[6:7] op_sel:[0,0,1] op_sel_hi:[1,0,1]
    v_cvt_pk_bf16_f32 v164, v12, v13
    v_cvt_pk_bf16_f32 v165, v14, v15
    v_cvt_pk_bf16_f32 v166, v16, v17
    v_cvt_pk_bf16_f32 v167, v18, v19
    buffer_store_dwordx4 v[164:167], v0, s[8:11], s35 offen sc1
    v_lshlrev_b32 v12, 16, v168
    v_and_b32 v13, s42, v168
    v_lshlrev_b32 v14, 16, v169
    v_and_b32 v15, s42, v169
    v_lshlrev_b32 v16, 16, v170
    v_and_b32 v17, s42, v170
    v_lshlrev_b32 v18, 16, v171
    v_and_b32 v19, s42, v171
    v_pk_fma_f32 v[12:13], v[12:13], s[38:39], v[6:7] op_sel:[0,0,1] op_sel_hi:[1,0,1]
    v_pk_fma_f32 v[14:15], v[14:15], s[38:39], v[6:7] op_sel:[0,0,1] op_sel_hi:[1,0,1]
    v_pk_fma_f32 v[16:17], v[16:17], s[38:39], v[6:7] op_sel:[0,0,1] op_sel_hi:[1,0,1]
    v_pk_fma_f32 v[18:19], v[18:19], s[38:39], v[6:7] op_sel:[0,0,1] op_sel_hi:[1,0,1]
    v_cvt_pk_bf16_f32 v168, v12, v13
    v_cvt_pk_bf16_f32 v169, v14, v15
    v_cvt_pk_bf16_f32 v170, v16, v17
    v_cvt_pk_bf16_f32 v171, v18, v19
    buffer_store_dwordx4 v[168:171], v0, s[8:11], s35 offen offset:1024 sc1
    s_add_u32 s35, s35, 131072
    v_readlane_b32 s40, v5, 10
    v_readlane_b32 s36, v4, 10
    s_nop 0
    v_mov_b32 v6, s40
    v_lshlrev_b32 v12, 16, v172
    v_and_b32 v13, s42, v172
    v_lshlrev_b32 v14, 16, v173
    v_and_b32 v15, s42, v173
    v_lshlrev_b32 v16, 16, v174
    v_and_b32 v17, s42, v174
    v_lshlrev_b32 v18, 16, v175
    v_and_b32 v19, s42, v175
    v_pk_fma_f32 v[12:13], v[12:13], s[36:37], v[6:7] op_sel_hi:[1,0,0]
    v_pk_fma_f32 v[14:15], v[14:15], s[36:37], v[6:7] op_sel_hi:[1,0,0]
    v_pk_fma_f32 v[16:17], v[16:17], s[36:37], v[6:7] op_sel_hi:[1,0,0]
    v_pk_fma_f32 v[18:19], v[18:19], s[36:37], v[6:7] op_sel_hi:[1,0,0]
    v_cvt_pk_bf16_f32 v172, v12, v13
    v_cvt_pk_bf16_f32 v173, v14, v15
    v_cvt_pk_bf16_f32 v174, v16, v17
    v_cvt_pk_bf16_f32 v175, v18, v19
    buffer_store_dwordx4 v[172:175], v0, s[8:11], s35 offen sc1
    v_lshlrev_b32 v12, 16, v176
    v_and_b32 v13, s42, v176
    v_lshlrev_b32 v14, 16, v177
    v_and_b32 v15, s42, v177
    v_lshlrev_b32 v16, 16, v178
    v_and_b32 v17, s42, v178
    v_lshlrev_b32 v18, 16, v179
    v_and_b32 v19, s42, v179
    v_pk_fma_f32 v[12:13], v[12:13], s[36:37], v[6:7] op_sel_hi:[1,0,0]
    v_pk_fma_f32 v[14:15], v[14:15], s[36:37], v[6:7] op_sel_hi:[1,0,0]
    v_pk_fma_f32 v[16:17], v[16:17], s[36:37], v[6:7] op_sel_hi:[1,0,0]
    v_pk_fma_f32 v[18:19], v[18:19], s[36:37], v[6:7] op_sel_hi:[1,0,0]
    v_cvt_pk_bf16_f32 v176, v12, v13
    v_cvt_pk_bf16_f32 v177, v14, v15
    v_cvt_pk_bf16_f32 v178, v16, v17
    v_cvt_pk_bf16_f32 v179, v18, v19
    buffer_store_dwordx4 v[176:179], v0, s[8:11], s35 offen offset:1024 sc1
    s_add_u32 s35, s35, 131072
    v_readlane_b32 s40, v5, 11
    v_readlane_b32 s38, v4, 11
    s_nop 0
    v_mov_b32 v7, s40
    v_lshlrev_b32 v12, 16, v180
    v_and_b32 v13, s42, v180
    v_lshlrev_b32 v14, 16, v181
    v_and_b32 v15, s42, v181
    v_lshlrev_b32 v16, 16, v182
    v_and_b32 v17, s42, v182
    v_lshlrev_b32 v18, 16, v183
    v_and_b32 v19, s42, v183
    v_pk_fma_f32 v[12:13], v[12:13], s[38:39], v[6:7] op_sel:[0,0,1] op_sel_hi:[1,0,1]
    v_pk_fma_f32 v[14:15], v[14:15], s[38:39], v[6:7] op_sel:[0,0,1] op_sel_hi:[1,0,1]
    v_pk_fma_f32 v[16:17], v[16:17], s[38:39], v[6:7] op_sel:[0,0,1] op_sel_hi:[1,0,1]
    v_pk_fma_f32 v[18:19], v[18:19], s[38:39], v[6:7] op_sel:[0,0,1] op_sel_hi:[1,0,1]
    v_cvt_pk_bf16_f32 v180, v12, v13
    v_cvt_pk_bf16_f32 v181, v14, v15
    v_cvt_pk_bf16_f32 v182, v16, v17
    v_cvt_pk_bf16_f32 v183, v18, v19
    buffer_store_dwordx4 v[180:183], v0, s[8:11], s35 offen sc1
    v_lshlrev_b32 v12, 16, v184
    v_and_b32 v13, s42, v184
    v_lshlrev_b32 v14, 16, v185
    v_and_b32 v15, s42, v185
    v_lshlrev_b32 v16, 16, v186
    v_and_b32 v17, s42, v186
    v_lshlrev_b32 v18, 16, v187
    v_and_b32 v19, s42, v187
    v_pk_fma_f32 v[12:13], v[12:13], s[38:39], v[6:7] op_sel:[0,0,1] op_sel_hi:[1,0,1]
    v_pk_fma_f32 v[14:15], v[14:15], s[38:39], v[6:7] op_sel:[0,0,1] op_sel_hi:[1,0,1]
    v_pk_fma_f32 v[16:17], v[16:17], s[38:39], v[6:7] op_sel:[0,0,1] op_sel_hi:[1,0,1]
    v_pk_fma_f32 v[18:19], v[18:19], s[38:39], v[6:7] op_sel:[0,0,1] op_sel_hi:[1,0,1]
    v_cvt_pk_bf16_f32 v184, v12, v13
    v_cvt_pk_bf16_f32 v185, v14, v15
    v_cvt_pk_bf16_f32 v186, v16, v17
    v_cvt_pk_bf16_f32 v187, v18, v19
    buffer_store_dwordx4 v[184:187], v0, s[8:11], s35 offen offset:1024 sc1
    s_add_u32 s35, s35, 131072
    v_readlane_b32 s40, v5, 12
    v_readlane_b32 s36, v4, 12
    s_nop 0
    v_mov_b32 v6, s40
    v_lshlrev_b32 v12, 16, v188
    v_and_b32 v13, s42, v188
    v_lshlrev_b32 v14, 16, v189
    v_and_b32 v15, s42, v189
    v_lshlrev_b32 v16, 16, v190
    v_and_b32 v17, s42, v190
    v_lshlrev_b32 v18, 16, v191
    v_and_b32 v19, s42, v191
    v_pk_fma_f32 v[12:13], v[12:13], s[36:37], v[6:7] op_sel_hi:[1,0,0]
    v_pk_fma_f32 v[14:15], v[14:15], s[36:37], v[6:7] op_sel_hi:[1,0,0]
    v_pk_fma_f32 v[16:17], v[16:17], s[36:37], v[6:7] op_sel_hi:[1,0,0]
    v_pk_fma_f32 v[18:19], v[18:19], s[36:37], v[6:7] op_sel_hi:[1,0,0]
    v_cvt_pk_bf16_f32 v188, v12, v13
    v_cvt_pk_bf16_f32 v189, v14, v15
    v_cvt_pk_bf16_f32 v190, v16, v17
    v_cvt_pk_bf16_f32 v191, v18, v19
    buffer_store_dwordx4 v[188:191], v0, s[8:11], s35 offen sc1
    v_lshlrev_b32 v12, 16, v192
    v_and_b32 v13, s42, v192
    v_lshlrev_b32 v14, 16, v193
    v_and_b32 v15, s42, v193
    v_lshlrev_b32 v16, 16, v194
    v_and_b32 v17, s42, v194
    v_lshlrev_b32 v18, 16, v195
    v_and_b32 v19, s42, v195
    v_pk_fma_f32 v[12:13], v[12:13], s[36:37], v[6:7] op_sel_hi:[1,0,0]
    v_pk_fma_f32 v[14:15], v[14:15], s[36:37], v[6:7] op_sel_hi:[1,0,0]
    v_pk_fma_f32 v[16:17], v[16:17], s[36:37], v[6:7] op_sel_hi:[1,0,0]
    v_pk_fma_f32 v[18:19], v[18:19], s[36:37], v[6:7] op_sel_hi:[1,0,0]
    v_cvt_pk_bf16_f32 v192, v12, v13
    v_cvt_pk_bf16_f32 v193, v14, v15
    v_cvt_pk_bf16_f32 v194, v16, v17
    v_cvt_pk_bf16_f32 v195, v18, v19
    buffer_store_dwordx4 v[192:195], v0, s[8:11], s35 offen offset:1024 sc1
    s_add_u32 s35, s35, 131072
    v_readlane_b32 s40, v5, 13
    v_readlane_b32 s38, v4, 13
    s_nop 0
    v_mov_b32 v7, s40
    v_lshlrev_b32 v12, 16, v196
    v_and_b32 v13, s42, v196
    v_lshlrev_b32 v14, 16, v197
    v_and_b32 v15, s42, v197
    v_lshlrev_b32 v16, 16, v198
    v_and_b32 v17, s42, v198
    v_lshlrev_b32 v18, 16, v199
    v_and_b32 v19, s42, v199
    v_pk_fma_f32 v[12:13], v[12:13], s[38:39], v[6:7] op_sel:[0,0,1] op_sel_hi:[1,0,1]
    v_pk_fma_f32 v[14:15], v[14:15], s[38:39], v[6:7] op_sel:[0,0,1] op_sel_hi:[1,0,1]
    v_pk_fma_f32 v[16:17], v[16:17], s[38:39], v[6:7] op_sel:[0,0,1] op_sel_hi:[1,0,1]
    v_pk_fma_f32 v[18:19], v[18:19], s[38:39], v[6:7] op_sel:[0,0,1] op_sel_hi:[1,0,1]
    v_cvt_pk_bf16_f32 v196, v12, v13
    v_cvt_pk_bf16_f32 v197, v14, v15
    v_cvt_pk_bf16_f32 v198, v16, v17
    v_cvt_pk_bf16_f32 v199, v18, v19
    buffer_store_dwordx4 v[196:199], v0, s[8:11], s35 offen sc1
    v_lshlrev_b32 v12, 16, v200
    v_and_b32 v13, s42, v200
    v_lshlrev_b32 v14, 16, v201
    v_and_b32 v15, s42, v201
    v_lshlrev_b32 v16, 16, v202
    v_and_b32 v17, s42, v202
    v_lshlrev_b32 v18, 16, v203
    v_and_b32 v19, s42, v203
    v_pk_fma_f32 v[12:13], v[12:13], s[38:39], v[6:7] op_sel:[0,0,1] op_sel_hi:[1,0,1]
    v_pk_fma_f32 v[14:15], v[14:15], s[38:39], v[6:7] op_sel:[0,0,1] op_sel_hi:[1,0,1]
    v_pk_fma_f32 v[16:17], v[16:17], s[38:39], v[6:7] op_sel:[0,0,1] op_sel_hi:[1,0,1]
    v_pk_fma_f32 v[18:19], v[18:19], s[38:39], v[6:7] op_sel:[0,0,1] op_sel_hi:[1,0,1]
    v_cvt_pk_bf16_f32 v200, v12, v13
    v_cvt_pk_bf16_f32 v201, v14, v15
    v_cvt_pk_bf16_f32 v202, v16, v17
    v_cvt_pk_bf16_f32 v203, v18, v19
    buffer_store_dwordx4 v[200:203], v0, s[8:11], s35 offen offset:1024 sc1
    s_add_u32 s35, s35, 131072
    v_readlane_b32 s40, v5, 14
    v_readlane_b32 s36, v4, 14
    s_nop 0
    v_mov_b32 v6, s40
    v_lshlrev_b32 v12, 16, v204
    v_and_b32 v13, s42, v204
    v_lshlrev_b32 v14, 16, v205
    v_and_b32 v15, s42, v205
    v_lshlrev_b32 v16, 16, v206
    v_and_b32 v17, s42, v206
    v_lshlrev_b32 v18, 16, v207
    v_and_b32 v19, s42, v207
    v_pk_fma_f32 v[12:13], v[12:13], s[36:37], v[6:7] op_sel_hi:[1,0,0]
    v_pk_fma_f32 v[14:15], v[14:15], s[36:37], v[6:7] op_sel_hi:[1,0,0]
    v_pk_fma_f32 v[16:17], v[16:17], s[36:37], v[6:7] op_sel_hi:[1,0,0]
    v_pk_fma_f32 v[18:19], v[18:19], s[36:37], v[6:7] op_sel_hi:[1,0,0]
    v_cvt_pk_bf16_f32 v204, v12, v13
    v_cvt_pk_bf16_f32 v205, v14, v15
    v_cvt_pk_bf16_f32 v206, v16, v17
    v_cvt_pk_bf16_f32 v207, v18, v19
    buffer_store_dwordx4 v[204:207], v1, s[8:11], s35 offen sc1
    v_lshlrev_b32 v12, 16, v208
    v_and_b32 v13, s42, v208
    v_lshlrev_b32 v14, 16, v209
    v_and_b32 v15, s42, v209
    v_lshlrev_b32 v16, 16, v210
    v_and_b32 v17, s42, v210
    v_lshlrev_b32 v18, 16, v211
    v_and_b32 v19, s42, v211
    v_pk_fma_f32 v[12:13], v[12:13], s[36:37], v[6:7] op_sel_hi:[1,0,0]
    v_pk_fma_f32 v[14:15], v[14:15], s[36:37], v[6:7] op_sel_hi:[1,0,0]
    v_pk_fma_f32 v[16:17], v[16:17], s[36:37], v[6:7] op_sel_hi:[1,0,0]
    v_pk_fma_f32 v[18:19], v[18:19], s[36:37], v[6:7] op_sel_hi:[1,0,0]
    v_cvt_pk_bf16_f32 v208, v12, v13
    v_cvt_pk_bf16_f32 v209, v14, v15
    v_cvt_pk_bf16_f32 v210, v16, v17
    v_cvt_pk_bf16_f32 v211, v18, v19
    buffer_store_dwordx4 v[208:211], v1, s[8:11], s35 offen offset:1024 sc1
    v_lshlrev_b32 v12, 16, v212
    v_and_b32 v13, s42, v212
    v_lshlrev_b32 v14, 16, v213
    v_and_b32 v15, s42, v213
    v_lshlrev_b32 v16, 16, v214
    v_and_b32 v17, s42, v214
    v_lshlrev_b32 v18, 16, v215
    v_and_b32 v19, s42, v215
    v_pk_fma_f32 v[12:13], v[12:13], s[36:37], v[6:7] op_sel_hi:[1,0,0]
    v_pk_fma_f32 v[14:15], v[14:15], s[36:37], v[6:7] op_sel_hi:[1,0,0]
    v_pk_fma_f32 v[16:17], v[16:17], s[36:37], v[6:7] op_sel_hi:[1,0,0]
    v_pk_fma_f32 v[18:19], v[18:19], s[36:37], v[6:7] op_sel_hi:[1,0,0]
    v_cvt_pk_bf16_f32 v212, v12, v13
    v_cvt_pk_bf16_f32 v213, v14, v15
    v_cvt_pk_bf16_f32 v214, v16, v17
    v_cvt_pk_bf16_f32 v215, v18, v19
    buffer_store_dwordx4 v[212:215], v1, s[8:11], s35 offen offset:2048 sc1
    s_add_u32 s35, s35, 131072
    v_readlane_b32 s40, v5, 15
    v_readlane_b32 s38, v4, 15
    s_nop 0
    v_mov_b32 v7, s40
    v_lshlrev_b32 v12, 16, v216
    v_and_b32 v13, s42, v216
    v_lshlrev_b32 v14, 16, v217
    v_and_b32 v15, s42, v217
    v_lshlrev_b32 v16, 16, v218
    v_and_b32 v17, s42, v218
    v_lshlrev_b32 v18, 16, v219
    v_and_b32 v19, s42, v219
    v_pk_fma_f32 v[12:13], v[12:13], s[38:39], v[6:7] op_sel:[0,0,1] op_sel_hi:[1,0,1]
    v_pk_fma_f32 v[14:15], v[14:15], s[38:39], v[6:7] op_sel:[0,0,1] op_sel_hi:[1,0,1]
    v_pk_fma_f32 v[16:17], v[16:17], s[38:39], v[6:7] op_sel:[0,0,1] op_sel_hi:[1,0,1]
    v_pk_fma_f32 v[18:19], v[18:19], s[38:39], v[6:7] op_sel:[0,0,1] op_sel_hi:[1,0,1]
    v_cvt_pk_bf16_f32 v216, v12, v13
    v_cvt_pk_bf16_f32 v217, v14, v15
    v_cvt_pk_bf16_f32 v218, v16, v17
    v_cvt_pk_bf16_f32 v219, v18, v19
    buffer_store_dwordx4 v[216:219], v1, s[8:11], s35 offen sc1
    v_lshlrev_b32 v12, 16, v220
    v_and_b32 v13, s42, v220
    v_lshlrev_b32 v14, 16, v221
    v_and_b32 v15, s42, v221
    v_lshlrev_b32 v16, 16, v222
    v_and_b32 v17, s42, v222
    v_lshlrev_b32 v18, 16, v223
    v_and_b32 v19, s42, v223
    v_pk_fma_f32 v[12:13], v[12:13], s[38:39], v[6:7] op_sel:[0,0,1] op_sel_hi:[1,0,1]
    v_pk_fma_f32 v[14:15], v[14:15], s[38:39], v[6:7] op_sel:[0,0,1] op_sel_hi:[1,0,1]
    v_pk_fma_f32 v[16:17], v[16:17], s[38:39], v[6:7] op_sel:[0,0,1] op_sel_hi:[1,0,1]
    v_pk_fma_f32 v[18:19], v[18:19], s[38:39], v[6:7] op_sel:[0,0,1] op_sel_hi:[1,0,1]
    v_cvt_pk_bf16_f32 v220, v12, v13
    v_cvt_pk_bf16_f32 v221, v14, v15
    v_cvt_pk_bf16_f32 v222, v16, v17
    v_cvt_pk_bf16_f32 v223, v18, v19
    buffer_store_dwordx4 v[220:223], v1, s[8:11], s35 offen offset:1024 sc1
    v_lshlrev_b32 v12, 16, v224
    v_and_b32 v13, s42, v224
    v_lshlrev_b32 v14, 16, v225
    v_and_b32 v15, s42, v225
    v_lshlrev_b32 v16, 16, v226
    v_and_b32 v17, s42, v226
    v_lshlrev_b32 v18, 16, v227
    v_and_b32 v19, s42, v227
    v_pk_fma_f32 v[12:13], v[12:13], s[38:39], v[6:7] op_sel:[0,0,1] op_sel_hi:[1,0,1]
    v_pk_fma_f32 v[14:15], v[14:15], s[38:39], v[6:7] op_sel:[0,0,1] op_sel_hi:[1,0,1]
    v_pk_fma_f32 v[16:17], v[16:17], s[38:39], v[6:7] op_sel:[0,0,1] op_sel_hi:[1,0,1]
    v_pk_fma_f32 v[18:19], v[18:19], s[38:39], v[6:7] op_sel:[0,0,1] op_sel_hi:[1,0,1]
    v_cvt_pk_bf16_f32 v224, v12, v13
    v_cvt_pk_bf16_f32 v225, v14, v15
    v_cvt_pk_bf16_f32 v226, v16, v17
    v_cvt_pk_bf16_f32 v227, v18, v19
    buffer_store_dwordx4 v[224:227], v1, s[8:11], s35 offen offset:2048 sc1
    s_add_u32 s35, s35, 131072
    v_readlane_b32 s40, v5, 16
    v_readlane_b32 s36, v4, 16
    s_nop 0
    v_mov_b32 v6, s40
    v_lshlrev_b32 v12, 16, v228
    v_and_b32 v13, s42, v228
    v_lshlrev_b32 v14, 16, v229
    v_and_b32 v15, s42, v229
    v_lshlrev_b32 v16, 16, v230
    v_and_b32 v17, s42, v230
    v_lshlrev_b32 v18, 16, v231
    v_and_b32 v19, s42, v231
    v_pk_fma_f32 v[12:13], v[12:13], s[36:37], v[6:7] op_sel_hi:[1,0,0]
    v_pk_fma_f32 v[14:15], v[14:15], s[36:37], v[6:7] op_sel_hi:[1,0,0]
    v_pk_fma_f32 v[16:17], v[16:17], s[36:37], v[6:7] op_sel_hi:[1,0,0]
    v_pk_fma_f32 v[18:19], v[18:19], s[36:37], v[6:7] op_sel_hi:[1,0,0]
    v_cvt_pk_bf16_f32 v228, v12, v13
    v_cvt_pk_bf16_f32 v229, v14, v15
    v_cvt_pk_bf16_f32 v230, v16, v17
    v_cvt_pk_bf16_f32 v231, v18, v19
    buffer_store_dwordx4 v[228:231], v1, s[8:11], s35 offen sc1
    v_lshlrev_b32 v12, 16, v232
    v_and_b32 v13, s42, v232
    v_lshlrev_b32 v14, 16, v233
    v_and_b32 v15, s42, v233
    v_lshlrev_b32 v16, 16, v234
    v_and_b32 v17, s42, v234
    v_lshlrev_b32 v18, 16, v235
    v_and_b32 v19, s42, v235
    v_pk_fma_f32 v[12:13], v[12:13], s[36:37], v[6:7] op_sel_hi:[1,0,0]
    v_pk_fma_f32 v[14:15], v[14:15], s[36:37], v[6:7] op_sel_hi:[1,0,0]
    v_pk_fma_f32 v[16:17], v[16:17], s[36:37], v[6:7] op_sel_hi:[1,0,0]
    v_pk_fma_f32 v[18:19], v[18:19], s[36:37], v[6:7] op_sel_hi:[1,0,0]
    v_cvt_pk_bf16_f32 v232, v12, v13
    v_cvt_pk_bf16_f32 v233, v14, v15
    v_cvt_pk_bf16_f32 v234, v16, v17
    v_cvt_pk_bf16_f32 v235, v18, v19
    buffer_store_dwordx4 v[232:235], v1, s[8:11], s35 offen offset:1024 sc1
    v_lshlrev_b32 v12, 16, v236
    v_and_b32 v13, s42, v236
    v_lshlrev_b32 v14, 16, v237
    v_and_b32 v15, s42, v237
    v_lshlrev_b32 v16, 16, v238
    v_and_b32 v17, s42, v238
    v_lshlrev_b32 v18, 16, v239
    v_and_b32 v19, s42, v239
    v_pk_fma_f32 v[12:13], v[12:13], s[36:37], v[6:7] op_sel_hi:[1,0,0]
    v_pk_fma_f32 v[14:15], v[14:15], s[36:37], v[6:7] op_sel_hi:[1,0,0]
    v_pk_fma_f32 v[16:17], v[16:17], s[36:37], v[6:7] op_sel_hi:[1,0,0]
    v_pk_fma_f32 v[18:19], v[18:19], s[36:37], v[6:7] op_sel_hi:[1,0,0]
    v_cvt_pk_bf16_f32 v236, v12, v13
    v_cvt_pk_bf16_f32 v237, v14, v15
    v_cvt_pk_bf16_f32 v238, v16, v17
    v_cvt_pk_bf16_f32 v239, v18, v19
    buffer_store_dwordx4 v[236:239], v1, s[8:11], s35 offen offset:2048 sc1
    s_add_u32 s35, s35, 131072
    v_readlane_b32 s40, v5, 17
    v_readlane_b32 s38, v4, 17
    s_nop 0
    v_mov_b32 v7, s40
    v_lshlrev_b32 v12, 16, v240
    v_and_b32 v13, s42, v240
    v_lshlrev_b32 v14, 16, v241
    v_and_b32 v15, s42, v241
    v_lshlrev_b32 v16, 16, v242
    v_and_b32 v17, s42, v242
    v_lshlrev_b32 v18, 16, v243
    v_and_b32 v19, s42, v243
    v_pk_fma_f32 v[12:13], v[12:13], s[38:39], v[6:7] op_sel:[0,0,1] op_sel_hi:[1,0,1]
    v_pk_fma_f32 v[14:15], v[14:15], s[38:39], v[6:7] op_sel:[0,0,1] op_sel_hi:[1,0,1]
    v_pk_fma_f32 v[16:17], v[16:17], s[38:39], v[6:7] op_sel:[0,0,1] op_sel_hi:[1,0,1]
    v_pk_fma_f32 v[18:19], v[18:19], s[38:39], v[6:7] op_sel:[0,0,1] op_sel_hi:[1,0,1]
    v_cvt_pk_bf16_f32 v240, v12, v13
    v_cvt_pk_bf16_f32 v241, v14, v15
    v_cvt_pk_bf16_f32 v242, v16, v17
    v_cvt_pk_bf16_f32 v243, v18, v19
    buffer_store_dwordx4 v[240:243], v1, s[8:11], s35 offen sc1
    v_lshlrev_b32 v12, 16, v244
    v_and_b32 v13, s42, v244
    v_lshlrev_b32 v14, 16, v245
    v_and_b32 v15, s42, v245
    v_lshlrev_b32 v16, 16, v246
    v_and_b32 v17, s42, v246
    v_lshlrev_b32 v18, 16, v247
    v_and_b32 v19, s42, v247
    v_pk_fma_f32 v[12:13], v[12:13], s[38:39], v[6:7] op_sel:[0,0,1] op_sel_hi:[1,0,1]
    v_pk_fma_f32 v[14:15], v[14:15], s[38:39], v[6:7] op_sel:[0,0,1] op_sel_hi:[1,0,1]
    v_pk_fma_f32 v[16:17], v[16:17], s[38:39], v[6:7] op_sel:[0,0,1] op_sel_hi:[1,0,1]
    v_pk_fma_f32 v[18:19], v[18:19], s[38:39], v[6:7] op_sel:[0,0,1] op_sel_hi:[1,0,1]
    v_cvt_pk_bf16_f32 v244, v12, v13
    v_cvt_pk_bf16_f32 v245, v14, v15
    v_cvt_pk_bf16_f32 v246, v16, v17
    v_cvt_pk_bf16_f32 v247, v18, v19
    buffer_store_dwordx4 v[244:247], v1, s[8:11], s35 offen offset:1024 sc1
    v_lshlrev_b32 v12, 16, v248
    v_and_b32 v13, s42, v248
    v_lshlrev_b32 v14, 16, v249
    v_and_b32 v15, s42, v249
    v_lshlrev_b32 v16, 16, v250
    v_and_b32 v17, s42, v250
    v_lshlrev_b32 v18, 16, v251
    v_and_b32 v19, s42, v251
    v_pk_fma_f32 v[12:13], v[12:13], s[38:39], v[6:7] op_sel:[0,0,1] op_sel_hi:[1,0,1]
    v_pk_fma_f32 v[14:15], v[14:15], s[38:39], v[6:7] op_sel:[0,0,1] op_sel_hi:[1,0,1]
    v_pk_fma_f32 v[16:17], v[16:17], s[38:39], v[6:7] op_sel:[0,0,1] op_sel_hi:[1,0,1]
    v_pk_fma_f32 v[18:19], v[18:19], s[38:39], v[6:7] op_sel:[0,0,1] op_sel_hi:[1,0,1]
    v_cvt_pk_bf16_f32 v248, v12, v13
    v_cvt_pk_bf16_f32 v249, v14, v15
    v_cvt_pk_bf16_f32 v250, v16, v17
    v_cvt_pk_bf16_f32 v251, v18, v19
    buffer_store_dwordx4 v[248:251], v1, s[8:11], s35 offen offset:2048 sc1
    s_endpgm
L_role1:
    s_lshr_b32 s40, s25, 1
    s_lshl_b32 s40, s40, 15
    s_lshl_b32 s41, s26, 10
    s_add_u32 s41, s41, 24576
    s_add_u32 s40, s40, s41
    v_subrev_u32 v1, s43, v2
    v_add_u32 v1, s40, v1
    s_add_u32 s27, s27, 131072
    buffer_load_dwordx4 v[204:207], v1, s[4:7], s27 offen nt
    s_add_u32 s27, s27, 131072
    buffer_load_dwordx4 v[208:211], v1, s[4:7], s27 offen nt
    s_waitcnt vmcnt(11)
    v_lshlrev_b32 v12, 16, v164
    v_and_b32 v13, s42, v164
    v_lshlrev_b32 v14, 16, v165
    v_and_b32 v15, s42, v165
    v_lshlrev_b32 v16, 16, v166
    v_and_b32 v17, s42, v166
    v_lshlrev_b32 v18, 16, v167
    v_and_b32 v19, s42, v167
    v_pk_add_f32 v[12:13], v[12:13], s[32:33] op_sel_hi:[1,0] neg_lo:[0,1] neg_hi:[0,1]
    v_pk_add_f32 v[14:15], v[14:15], s[32:33] op_sel_hi:[1,0] neg_lo:[0,1] neg_hi:[0,1]
    v_pk_add_f32 v[16:17], v[16:17], s[32:33] op_sel_hi:[1,0] neg_lo:[0,1] neg_hi:[0,1]
    v_pk_add_f32 v[18:19], v[18:19], s[32:33] op_sel_hi:[1,0] neg_lo:[0,1] neg_hi:[0,1]
    v_pk_add_f32 v[8:9], v[8:9], v[12:13]
    v_pk_fma_f32 v[10:11], v[12:13], v[12:13], v[10:11]
    v_pk_add_f32 v[8:9], v[8:9], v[14:15]
    v_pk_fma_f32 v[10:11], v[14:15], v[14:15], v[10:11]
    v_pk_add_f32 v[8:9], v[8:9], v[16:17]
    v_pk_fma_f32 v[10:11], v[16:17], v[16:17], v[10:11]
    v_pk_add_f32 v[8:9], v[8:9], v[18:19]
    v_pk_fma_f32 v[10:11], v[18:19], v[18:19], v[10:11]
    s_add_u32 s27, s27, 131072
    buffer_load_dwordx4 v[212:215], v1, s[4:7], s27 offen nt
    s_waitcnt vmcnt(11)
    v_lshlrev_b32 v12, 16, v168
    v_and_b32 v13, s42, v168
    v_lshlrev_b32 v14, 16, v169
    v_and_b32 v15, s42, v169
    v_lshlrev_b32 v16, 16, v170
    v_and_b32 v17, s42, v170
    v_lshlrev_b32 v18, 16, v171
    v_and_b32 v19, s42, v171
    v_pk_add_f32 v[12:13], v[12:13], s[32:33] op_sel_hi:[1,0] neg_lo:[0,1] neg_hi:[0,1]
    v_pk_add_f32 v[14:15], v[14:15], s[32:33] op_sel_hi:[1,0] neg_lo:[0,1] neg_hi:[0,1]
    v_pk_add_f32 v[16:17], v[16:17], s[32:33] op_sel_hi:[1,0] neg_lo:[0,1] neg_hi:[0,1]
    v_pk_add_f32 v[18:19], v[18:19], s[32:33] op_sel_hi:[1,0] neg_lo:[0,1] neg_hi:[0,1]
    v_pk_add_f32 v[8:9], v[8:9], v[12:13]
    v_pk_fma_f32 v[10:11], v[12:13], v[12:13], v[10:11]
    v_pk_add_f32 v[8:9], v[8:9], v[14:15]
    v_pk_fma_f32 v[10:11], v[14:15], v[14:15], v[10:11]
    v_pk_add_f32 v[8:9], v[8:9], v[16:17]
    v_pk_fma_f32 v[10:11], v[16:17], v[16:17], v[10:11]
    v_pk_add_f32 v[8:9], v[8:9], v[18:19]
    v_pk_fma_f32 v[10:11], v[18:19], v[18:19], v[10:11]
    s_add_u32 s27, s27, 131072
    buffer_load_dwordx4 v[216:219], v1, s[4:7], s27 offen nt
    s_waitcnt vmcnt(11)
    v_lshlrev_b32 v12, 16, v172
    v_and_b32 v13, s42, v172
    v_lshlrev_b32 v14, 16, v173
    v_and_b32 v15, s42, v173
    v_lshlrev_b32 v16, 16, v174
    v_and_b32 v17, s42, v174
    v_lshlrev_b32 v18, 16, v175
    v_and_b32 v19, s42, v175
    v_pk_add_f32 v[12:13], v[12:13], s[32:33] op_sel_hi:[1,0] neg_lo:[0,1] neg_hi:[0,1]
    v_pk_add_f32 v[14:15], v[14:15], s[32:33] op_sel_hi:[1,0] neg_lo:[0,1] neg_hi:[0,1]
    v_pk_add_f32 v[16:17], v[16:17], s[32:33] op_sel_hi:[1,0] neg_lo:[0,1] neg_hi:[0,1]
    v_pk_add_f32 v[18:19], v[18:19], s[32:33] op_sel_hi:[1,0] neg_lo:[0,1] neg_hi:[0,1]
    v_pk_add_f32 v[8:9], v[8:9], v[12:13]
    v_pk_fma_f32 v[10:11], v[12:13], v[12:13], v[10:11]
    v_pk_add_f32 v[8:9], v[8:9], v[14:15]
    v_pk_fma_f32 v[10:11], v[14:15], v[14:15], v[10:11]
    v_pk_add_f32 v[8:9], v[8:9], v[16:17]
    v_pk_fma_f32 v[10:11], v[16:17], v[16:17], v[10:11]
    v_pk_add_f32 v[8:9], v[8:9], v[18:19]
    v_pk_fma_f32 v[10:11], v[18:19], v[18:19], v[10:11]
    s_waitcnt vmcnt(10)
    v_lshlrev_b32 v12, 16, v176
    v_and_b32 v13, s42, v176
    v_lshlrev_b32 v14, 16, v177
    v_and_b32 v15, s42, v177
    v_lshlrev_b32 v16, 16, v178
    v_and_b32 v17, s42, v178
    v_lshlrev_b32 v18, 16, v179
    v_and_b32 v19, s42, v179
    v_pk_add_f32 v[12:13], v[12:13], s[32:33] op_sel_hi:[1,0] neg_lo:[0,1] neg_hi:[0,1]
    v_pk_add_f32 v[14:15], v[14:15], s[32:33] op_sel_hi:[1,0] neg_lo:[0,1] neg_hi:[0,1]
    v_pk_add_f32 v[16:17], v[16:17], s[32:33] op_sel_hi:[1,0] neg_lo:[0,1] neg_hi:[0,1]
    v_pk_add_f32 v[18:19], v[18:19], s[32:33] op_sel_hi:[1,0] neg_lo:[0,1] neg_hi:[0,1]
    v_pk_add_f32 v[8:9], v[8:9], v[12:13]
    v_pk_fma_f32 v[10:11], v[12:13], v[12:13], v[10:11]
    v_pk_add_f32 v[8:9], v[8:9], v[14:15]
    v_pk_fma_f32 v[10:11], v[14:15], v[14:15], v[10:11]
    v_pk_add_f32 v[8:9], v[8:9], v[16:17]
    v_pk_fma_f32 v[10:11], v[16:17], v[16:17], v[10:11]
    v_pk_add_f32 v[8:9], v[8:9], v[18:19]
    v_pk_fma_f32 v[10:11], v[18:19], v[18:19], v[10:11]
    s_waitcnt vmcnt(9)
    v_lshlrev_b32 v12, 16, v180
    v_and_b32 v13, s42, v180
    v_lshlrev_b32 v14, 16, v181
    v_and_b32 v15, s42, v181
    v_lshlrev_b32 v16, 16, v182
    v_and_b32 v17, s42, v182
    v_lshlrev_b32 v18, 16, v183
    v_and_b32 v19, s42, v183
    v_pk_add_f32 v[12:13], v[12:13], s[32:33] op_sel_hi:[1,0] neg_lo:[0,1] neg_hi:[0,1]
    v_pk_add_f32 v[14:15], v[14:15], s[32:33] op_sel_hi:[1,0] neg_lo:[0,1] neg_hi:[0,1]
    v_pk_add_f32 v[16:17], v[16:17], s[32:33] op_sel_hi:[1,0] neg_lo:[0,1] neg_hi:[0,1]
    v_pk_add_f32 v[18:19], v[18:19], s[32:33] op_sel_hi:[1,0] neg_lo:[0,1] neg_hi:[0,1]
    v_pk_add_f32 v[8:9], v[8:9], v[12:13]
    v_pk_fma_f32 v[10:11], v[12:13], v[12:13], v[10:11]
    v_pk_add_f32 v[8:9], v[8:9], v[14:15]
    v_pk_fma_f32 v[10:11], v[14:15], v[14:15], v[10:11]
    v_pk_add_f32 v[8:9], v[8:9], v[16:17]
    v_pk_fma_f32 v[10:11], v[16:17], v[16:17], v[10:11]
    v_pk_add_f32 v[8:9], v[8:9], v[18:19]
    v_pk_fma_f32 v[10:11], v[18:19], v[18:19], v[10:11]
    s_waitcnt vmcnt(8)
    v_lshlrev_b32 v12, 16, v184
    v_and_b32 v13, s42, v184
    v_lshlrev_b32 v14, 16, v185
    v_and_b32 v15, s42, v185
    v_lshlrev_b32 v16, 16, v186
    v_and_b32 v17, s42, v186
    v_lshlrev_b32 v18, 16, v187
    v_and_b32 v19, s42, v187
    v_pk_add_f32 v[12:13], v[12:13], s[32:33] op_sel_hi:[1,0] neg_lo:[0,1] neg_hi:[0,1]
    v_pk_add_f32 v[14:15], v[14:15], s[32:33] op_sel_hi:[1,0] neg_lo:[0,1] neg_hi:[0,1]
    v_pk_add_f32 v[16:17], v[16:17], s[32:33] op_sel_hi:[1,0] neg_lo:[0,1] neg_hi:[0,1]
    v_pk_add_f32 v[18:19], v[18:19], s[32:33] op_sel_hi:[1,0] neg_lo:[0,1] neg_hi:[0,1]
    v_pk_add_f32 v[8:9], v[8:9], v[12:13]
    v_pk_fma_f32 v[10:11], v[12:13], v[12:13], v[10:11]
    v_pk_add_f32 v[8:9], v[8:9], v[14:15]
    v_pk_fma_f32 v[10:11], v[14:15], v[14:15], v[10:11]
    v_pk_add_f32 v[8:9], v[8:9], v[16:17]
    v_pk_fma_f32 v[10:11], v[16:17], v[16:17], v[10:11]
    v_pk_add_f32 v[8:9], v[8:9], v[18:19]
    v_pk_fma_f32 v[10:11], v[18:19], v[18:19], v[10:11]
    s_waitcnt vmcnt(7)
    v_lshlrev_b32 v12, 16, v188
    v_and_b32 v13, s42, v188
    v_lshlrev_b32 v14, 16, v189
    v_and_b32 v15, s42, v189
    v_lshlrev_b32 v16, 16, v190
    v_and_b32 v17, s42, v190
    v_lshlrev_b32 v18, 16, v191
    v_and_b32 v19, s42, v191
    v_pk_add_f32 v[12:13], v[12:13], s[32:33] op_sel_hi:[1,0] neg_lo:[0,1] neg_hi:[0,1]
    v_pk_add_f32 v[14:15], v[14:15], s[32:33] op_sel_hi:[1,0] neg_lo:[0,1] neg_hi:[0,1]
    v_pk_add_f32 v[16:17], v[16:17], s[32:33] op_sel_hi:[1,0] neg_lo:[0,1] neg_hi:[0,1]
    v_pk_add_f32 v[18:19], v[18:19], s[32:33] op_sel_hi:[1,0] neg_lo:[0,1] neg_hi:[0,1]
    v_pk_add_f32 v[8:9], v[8:9], v[12:13]
    v_pk_fma_f32 v[10:11], v[12:13], v[12:13], v[10:11]
    v_pk_add_f32 v[8:9], v[8:9], v[14:15]
    v_pk_fma_f32 v[10:11], v[14:15], v[14:15], v[10:11]
    v_pk_add_f32 v[8:9], v[8:9], v[16:17]
    v_pk_fma_f32 v[10:11], v[16:17], v[16:17], v[10:11]
    v_pk_add_f32 v[8:9], v[8:9], v[18:19]
    v_pk_fma_f32 v[10:11], v[18:19], v[18:19], v[10:11]
    s_waitcnt vmcnt(6)
    v_lshlrev_b32 v12, 16, v192
    v_and_b32 v13, s42, v192
    v_lshlrev_b32 v14, 16, v193
    v_and_b32 v15, s42, v193
    v_lshlrev_b32 v16, 16, v194
    v_and_b32 v17, s42, v194
    v_lshlrev_b32 v18, 16, v195
    v_and_b32 v19, s42, v195
    v_pk_add_f32 v[12:13], v[12:13], s[32:33] op_sel_hi:[1,0] neg_lo:[0,1] neg_hi:[0,1]
    v_pk_add_f32 v[14:15], v[14:15], s[32:33] op_sel_hi:[1,0] neg_lo:[0,1] neg_hi:[0,1]
    v_pk_add_f32 v[16:17], v[16:17], s[32:33] op_sel_hi:[1,0] neg_lo:[0,1] neg_hi:[0,1]
    v_pk_add_f32 v[18:19], v[18:19], s[32:33] op_sel_hi:[1,0] neg_lo:[0,1] neg_hi:[0,1]
    v_pk_add_f32 v[8:9], v[8:9], v[12:13]
    v_pk_fma_f32 v[10:11], v[12:13], v[12:13], v[10:11]
    v_pk_add_f32 v[8:9], v[8:9], v[14:15]
    v_pk_fma_f32 v[10:11], v[14:15], v[14:15], v[10:11]
    v_pk_add_f32 v[8:9], v[8:9], v[16:17]
    v_pk_fma_f32 v[10:11], v[16:17], v[16:17], v[10:11]
    v_pk_add_f32 v[8:9], v[8:9], v[18:19]
    v_pk_fma_f32 v[10:11], v[18:19], v[18:19], v[10:11]
    s_waitcnt vmcnt(5)
    v_lshlrev_b32 v12, 16, v196
    v_and_b32 v13, s42, v196
    v_lshlrev_b32 v14, 16, v197
    v_and_b32 v15, s42, v197
    v_lshlrev_b32 v16, 16, v198
    v_and_b32 v17, s42, v198
    v_lshlrev_b32 v18, 16, v199
    v_and_b32 v19, s42, v199
    v_pk_add_f32 v[12:13], v[12:13], s[32:33] op_sel_hi:[1,0] neg_lo:[0,1] neg_hi:[0,1]
    v_pk_add_f32 v[14:15], v[14:15], s[32:33] op_sel_hi:[1,0] neg_lo:[0,1] neg_hi:[0,1]
    v_pk_add_f32 v[16:17], v[16:17], s[32:33] op_sel_hi:[1,0] neg_lo:[0,1] neg_hi:[0,1]
    v_pk_add_f32 v[18:19], v[18:19], s[32:33] op_sel_hi:[1,0] neg_lo:[0,1] neg_hi:[0,1]
    v_pk_add_f32 v[8:9], v[8:9], v[12:13]
    v_pk_fma_f32 v[10:11], v[12:13], v[12:13], v[10:11]
    v_pk_add_f32 v[8:9], v[8:9], v[14:15]
    v_pk_fma_f32 v[10:11], v[14:15], v[14:15], v[10:11]
    v_pk_add_f32 v[8:9], v[8:9], v[16:17]
    v_pk_fma_f32 v[10:11], v[16:17], v[16:17], v[10:11]
    v_pk_add_f32 v[8:9], v[8:9], v[18:19]
    v_pk_fma_f32 v[10:11], v[18:19], v[18:19], v[10:11]
    s_waitcnt vmcnt(4)
    v_lshlrev_b32 v12, 16, v200
    v_and_b32 v13, s42, v200
    v_lshlrev_b32 v14, 16, v201
    v_and_b32 v15, s42, v201
    v_lshlrev_b32 v16, 16, v202
    v_and_b32 v17, s42, v202
    v_lshlrev_b32 v18, 16, v203
    v_and_b32 v19, s42, v203
    v_pk_add_f32 v[12:13], v[12:13], s[32:33] op_sel_hi:[1,0] neg_lo:[0,1] neg_hi:[0,1]
    v_pk_add_f32 v[14:15], v[14:15], s[32:33] op_sel_hi:[1,0] neg_lo:[0,1] neg_hi:[0,1]
    v_pk_add_f32 v[16:17], v[16:17], s[32:33] op_sel_hi:[1,0] neg_lo:[0,1] neg_hi:[0,1]
    v_pk_add_f32 v[18:19], v[18:19], s[32:33] op_sel_hi:[1,0] neg_lo:[0,1] neg_hi:[0,1]
    v_pk_add_f32 v[8:9], v[8:9], v[12:13]
    v_pk_fma_f32 v[10:11], v[12:13], v[12:13], v[10:11]
    v_pk_add_f32 v[8:9], v[8:9], v[14:15]
    v_pk_fma_f32 v[10:11], v[14:15], v[14:15], v[10:11]
    v_pk_add_f32 v[8:9], v[8:9], v[16:17]
    v_pk_fma_f32 v[10:11], v[16:17], v[16:17], v[10:11]
    v_pk_add_f32 v[8:9], v[8:9], v[18:19]
    v_pk_fma_f32 v[10:11], v[18:19], v[18:19], v[10:11]
    s_waitcnt vmcnt(3)
    v_lshlrev_b32 v12, 16, v204
    v_and_b32 v13, s42, v204
    v_lshlrev_b32 v14, 16, v205
    v_and_b32 v15, s42, v205
    v_lshlrev_b32 v16, 16, v206
    v_and_b32 v17, s42, v206
    v_lshlrev_b32 v18, 16, v207
    v_and_b32 v19, s42, v207
    v_pk_add_f32 v[12:13], v[12:13], s[32:33] op_sel_hi:[1,0] neg_lo:[0,1] neg_hi:[0,1]
    v_pk_add_f32 v[14:15], v[14:15], s[32:33] op_sel_hi:[1,0] neg_lo:[0,1] neg_hi:[0,1]
    v_pk_add_f32 v[16:17], v[16:17], s[32:33] op_sel_hi:[1,0] neg_lo:[0,1] neg_hi:[0,1]
    v_pk_add_f32 v[18:19], v[18:19], s[32:33] op_sel_hi:[1,0] neg_lo:[0,1] neg_hi:[0,1]
    v_pk_add_f32 v[8:9], v[8:9], v[12:13]
    v_pk_fma_f32 v[10:11], v[12:13], v[12:13], v[10:11]
    v_pk_add_f32 v[8:9], v[8:9], v[14:15]
    v_pk_fma_f32 v[10:11], v[14:15], v[14:15], v[10:11]
    v_pk_add_f32 v[8:9], v[8:9], v[16:17]
    v_pk_fma_f32 v[10:11], v[16:17], v[16:17], v[10:11]
    v_pk_add_f32 v[8:9], v[8:9], v[18:19]
    v_pk_fma_f32 v[10:11], v[18:19], v[18:19], v[10:11]
    s_waitcnt vmcnt(2)
    v_lshlrev_b32 v12, 16, v208
    v_and_b32 v13, s42, v208
    v_lshlrev_b32 v14, 16, v209
    v_and_b32 v15, s42, v209
    v_lshlrev_b32 v16, 16, v210
    v_and_b32 v17, s42, v210
    v_lshlrev_b32 v18, 16, v211
    v_and_b32 v19, s42, v211
    v_pk_add_f32 v[12:13], v[12:13], s[32:33] op_sel_hi:[1,0] neg_lo:[0,1] neg_hi:[0,1]
    v_pk_add_f32 v[14:15], v[14:15], s[32:33] op_sel_hi:[1,0] neg_lo:[0,1] neg_hi:[0,1]
    v_pk_add_f32 v[16:17], v[16:17], s[32:33] op_sel_hi:[1,0] neg_lo:[0,1] neg_hi:[0,1]
    v_pk_add_f32 v[18:19], v[18:19], s[32:33] op_sel_hi:[1,0] neg_lo:[0,1] neg_hi:[0,1]
    v_pk_add_f32 v[8:9], v[8:9], v[12:13]
    v_pk_fma_f32 v[10:11], v[12:13], v[12:13], v[10:11]
    v_pk_add_f32 v[8:9], v[8:9], v[14:15]
    v_pk_fma_f32 v[10:11], v[14:15], v[14:15], v[10:11]
    v_pk_add_f32 v[8:9], v[8:9], v[16:17]
    v_pk_fma_f32 v[10:11], v[16:17], v[16:17], v[10:11]
    v_pk_add_f32 v[8:9], v[8:9], v[18:19]
    v_pk_fma_f32 v[10:11], v[18:19], v[18:19], v[10:11]
    s_waitcnt vmcnt(1)
    v_lshlrev_b32 v12, 16, v212
    v_and_b32 v13, s42, v212
    v_lshlrev_b32 v14, 16, v213
    v_and_b32 v15, s42, v213
    v_lshlrev_b32 v16, 16, v214
    v_and_b32 v17, s42, v214
    v_lshlrev_b32 v18, 16, v215
    v_and_b32 v19, s42, v215
    v_pk_add_f32 v[12:13], v[12:13], s[32:33] op_sel_hi:[1,0] neg_lo:[0,1] neg_hi:[0,1]
    v_pk_add_f32 v[14:15], v[14:15], s[32:33] op_sel_hi:[1,0] neg_lo:[0,1] neg_hi:[0,1]
    v_pk_add_f32 v[16:17], v[16:17], s[32:33] op_sel_hi:[1,0] neg_lo:[0,1] neg_hi:[0,1]
    v_pk_add_f32 v[18:19], v[18:19], s[32:33] op_sel_hi:[1,0] neg_lo:[0,1] neg_hi:[0,1]
    v_pk_add_f32 v[8:9], v[8:9], v[12:13]
    v_pk_fma_f32 v[10:11], v[12:13], v[12:13], v[10:11]
    v_pk_add_f32 v[8:9], v[8:9], v[14:15]
    v_pk_fma_f32 v[10:11], v[14:15], v[14:15], v[10:11]
    v_pk_add_f32 v[8:9], v[8:9], v[16:17]
    v_pk_fma_f32 v[10:11], v[16:17], v[16:17], v[10:11]
    v_pk_add_f32 v[8:9], v[8:9], v[18:19]
    v_pk_fma_f32 v[10:11], v[18:19], v[18:19], v[10:11]
    s_waitcnt vmcnt(0)
    v_lshlrev_b32 v12, 16, v216
    v_and_b32 v13, s42, v216
    v_lshlrev_b32 v14, 16, v217
    v_and_b32 v15, s42, v217
    v_lshlrev_b32 v16, 16, v218
    v_and_b32 v17, s42, v218
    v_lshlrev_b32 v18, 16, v219
    v_and_b32 v19, s42, v219
    v_pk_add_f32 v[12:13], v[12:13], s[32:33] op_sel_hi:[1,0] neg_lo:[0,1] neg_hi:[0,1]
    v_pk_add_f32 v[14:15], v[14:15], s[32:33] op_sel_hi:[1,0] neg_lo:[0,1] neg_hi:[0,1]
    v_pk_add_f32 v[16:17], v[16:17], s[32:33] op_sel_hi:[1,0] neg_lo:[0,1] neg_hi:[0,1]
    v_pk_add_f32 v[18:19], v[18:19], s[32:33] op_sel_hi:[1,0] neg_lo:[0,1] neg_hi:[0,1]
    v_pk_add_f32 v[8:9], v[8:9], v[12:13]
    v_pk_fma_f32 v[10:11], v[12:13], v[12:13], v[10:11]
    v_pk_add_f32 v[8:9], v[8:9], v[14:15]
    v_pk_fma_f32 v[10:11], v[14:15], v[14:15], v[10:11]
    v_pk_add_f32 v[8:9], v[8:9], v[16:17]
    v_pk_fma_f32 v[10:11], v[16:17], v[16:17], v[10:11]
    v_pk_add_f32 v[8:9], v[8:9], v[18:19]
    v_pk_fma_f32 v[10:11], v[18:19], v[18:19], v[10:11]
    v_add_f32 v12, v8, v9
    v_add_f32 v14, v10, v11
    s_nop 1
    v_add_f32_dpp v12, v12, v12 row_shr:1 row_mask:0xf bank_mask:0xf
    v_add_f32_dpp v14, v14, v14 row_shr:1 row_mask:0xf bank_mask:0xf
    s_nop 1
    v_add_f32_dpp v12, v12, v12 row_shr:2 row_mask:0xf bank_mask:0xf
    v_add_f32_dpp v14, v14, v14 row_shr:2 row_mask:0xf bank_mask:0xf
    s_nop 1
    v_add_f32_dpp v12, v12, v12 row_shr:4 row_mask:0xf bank_mask:0xf
    v_add_f32_dpp v14, v14, v14 row_shr:4 row_mask:0xf bank_mask:0xf
    s_nop 1
    v_add_f32_dpp v12, v12, v12 row_shr:8 row_mask:0xf bank_mask:0xf
    v_add_f32_dpp v14, v14, v14 row_shr:8 row_mask:0xf bank_mask:0xf
    s_nop 1
    v_add_f32_dpp v12, v12, v12 row_bcast:15 row_mask:0xa bank_mask:0xf
    v_add_f32_dpp v14, v14, v14 row_bcast:15 row_mask:0xa bank_mask:0xf
    s_nop 1
    v_add_f32_dpp v12, v12, v12 row_bcast:31 row_mask:0xc bank_mask:0xf
    v_add_f32_dpp v14, v14, v14 row_bcast:31 row_mask:0xc bank_mask:0xf
    v_mov_b32 v13, s34
    v_mov_b32 v15, s65
    s_lshl_b32 s57, s26, 4
    s_add_u32 s57, s57, 147584
    v_mov_b32 v16, s57
    v_subrev_u32 v17, s43, v2
    v_add_u32 v17, 147584, v17
    s_lshl_b64 exec, 1, 63
    ds_write_b128 v16, v[12:15]
    s_mov_b64 exec, 0xff
    ds_read_b128 v[12:15], v17
    s_waitcnt lgkmcnt(0)
    v_cmp_eq_u32 vcc, s34, v13
    v_cmp_eq_u32 s[58:59], s65, v15
    s_add_u32 s56, s56, 128
    s_nop 0
    s_and_b64 vcc, vcc, s[58:59]
    s_cmp_eq_u64 vcc, exec
    s_cbranch_scc0 L_nopub_8
    s_nop 1
    v_add_f32_dpp v12, v12, v12 row_shr:1 row_mask:0xf bank_mask:0xf
    v_add_f32_dpp v14, v14, v14 row_shr:1 row_mask:0xf bank_mask:0xf
    s_nop 1
    v_add_f32_dpp v12, v12, v12 row_shr:2 row_mask:0xf bank_mask:0xf
    v_add_f32_dpp v14, v14, v14 row_shr:2 row_mask:0xf bank_mask:0xf
    s_nop 1
    v_add_f32_dpp v12, v12, v12 row_shr:4 row_mask:0xf bank_mask:0xf
    v_add_f32_dpp v14, v14, v14 row_shr:4 row_mask:0xf bank_mask:0xf
    s_mov_b64 exec, 0x80
    buffer_store_dwordx4 v[12:15], off, s[12:15], s56 sc1
L_nopub_8:
    s_mov_b64 exec, -1
    s_mov_b32 s35, s28
    v_readlane_b32 s40, v5, 0
    v_readlane_b32 s36, v4, 0
    s_nop 0
    v_mov_b32 v6, s40
    ds_read_b128 v[16:19], v2 offset:0
    s_waitcnt lgkmcnt(0)
    v_lshlrev_b32 v12, 16, v16
    v_and_b32 v13, s42, v16
    v_lshlrev_b32 v14, 16, v17
    v_and_b32 v15, s42, v17
    v_lshlrev_b32 v16, 16, v18
    v_and_b32 v17, s42, v18
    v_lshlrev_b32 v18, 16, v19
    v_and_b32 v19, s42, v19
    v_pk_fma_f32 v[12:13], v[12:13], s[36:37], v[6:7] op_sel_hi:[1,0,0]
    v_pk_fma_f32 v[14:15], v[14:15], s[36:37], v[6:7] op_sel_hi:[1,0,0]
    v_pk_fma_f32 v[16:17], v[16:17], s[36:37], v[6:7] op_sel_hi:[1,0,0]
    v_pk_fma_f32 v[18:19], v[18:19], s[36:37], v[6:7] op_sel_hi:[1,0,0]
    v_cvt_pk_bf16_f32 v12, v12, v13
    v_cvt_pk_bf16_f32 v13, v14, v15
    v_cvt_pk_bf16_f32 v14, v16, v17
    v_cvt_pk_bf16_f32 v15, v18, v19
    buffer_store_dwordx4 v[12:15], v0, s[8:11], s35 offen sc1
    s_nop 1
    ds_read_b128 v[16:19], v2 offset:1024
    s_waitcnt lgkmcnt(0)
    v_lshlrev_b32 v12, 16, v16
    v_and_b32 v13, s42, v16
    v_lshlrev_b32 v14, 16, v17
    v_and_b32 v15, s42, v17
    v_lshlrev_b32 v16, 16, v18
    v_and_b32 v17, s42, v18
    v_lshlrev_b32 v18, 16, v19
    v_and_b32 v19, s42, v19
    v_pk_fma_f32 v[12:13], v[12:13], s[36:37], v[6:7] op_sel_hi:[1,0,0]
    v_pk_fma_f32 v[14:15], v[14:15], s[36:37], v[6:7] op_sel_hi:[1,0,0]
    v_pk_fma_f32 v[16:17], v[16:17], s[36:37], v[6:7] op_sel_hi:[1,0,0]
    v_pk_fma_f32 v[18:19], v[18:19], s[36:37], v[6:7] op_sel_hi:[1,0,0]
    v_cvt_pk_bf16_f32 v12, v12, v13
    v_cvt_pk_bf16_f32 v13, v14, v15
    v_cvt_pk_bf16_f32 v14, v16, v17
    v_cvt_pk_bf16_f32 v15, v18, v19
    buffer_store_dwordx4 v[12:15], v0, s[8:11], s35 offen offset:1024 sc1
    s_nop 1
    s_add_u32 s35, s35, 131072
    v_readlane_b32 s40, v5, 1
    v_readlane_b32 s38, v4, 1
    s_nop 0
    v_mov_b32 v7, s40
    ds_read_b128 v[16:19], v2 offset:2048
    s_waitcnt lgkmcnt(0)
    v_lshlrev_b32 v12, 16, v16
    v_and_b32 v13, s42, v16
    v_lshlrev_b32 v14, 16, v17
    v_and_b32 v15, s42, v17
    v_lshlrev_b32 v16, 16, v18
    v_and_b32 v17, s42, v18
    v_lshlrev_b32 v18, 16, v19
    v_and_b32 v19, s42, v19
    v_pk_fma_f32 v[12:13], v[12:13], s[38:39], v[6:7] op_sel:[0,0,1] op_sel_hi:[1,0,1]
    v_pk_fma_f32 v[14:15], v[14:15], s[38:39], v[6:7] op_sel:[0,0,1] op_sel_hi:[1,0,1]
    v_pk_fma_f32 v[16:17], v[16:17], s[38:39], v[6:7] op_sel:[0,0,1] op_sel_hi:[1,0,1]
    v_pk_fma_f32 v[18:19], v[18:19], s[38:39], v[6:7] op_sel:[0,0,1] op_sel_hi:[1,0,1]
    v_cvt_pk_bf16_f32 v12, v12, v13
    v_cvt_pk_bf16_f32 v13, v14, v15
    v_cvt_pk_bf16_f32 v14, v16, v17
    v_cvt_pk_bf16_f32 v15, v18, v19
    buffer_store_dwordx4 v[12:15], v0, s[8:11], s35 offen sc1
    s_nop 1
    ds_read_b128 v[16:19], v2 offset:3072
    s_waitcnt lgkmcnt(0)
    v_lshlrev_b32 v12, 16, v16
    v_and_b32 v13, s42, v16
    v_lshlrev_b32 v14, 16, v17
    v_and_b32 v15, s42, v17
    v_lshlrev_b32 v16, 16, v18
    v_and_b32 v17, s42, v18
    v_lshlrev_b32 v18, 16, v19
    v_and_b32 v19, s42, v19
    v_pk_fma_f32 v[12:13], v[12:13], s[38:39], v[6:7] op_sel:[0,0,1] op_sel_hi:[1,0,1]
    v_pk_fma_f32 v[14:15], v[14:15], s[38:39], v[6:7] op_sel:[0,0,1] op_sel_hi:[1,0,1]
    v_pk_fma_f32 v[16:17], v[16:17], s[38:39], v[6:7] op_sel:[0,0,1] op_sel_hi:[1,0,1]
    v_pk_fma_f32 v[18:19], v[18:19], s[38:39], v[6:7] op_sel:[0,0,1] op_sel_hi:[1,0,1]
    v_cvt_pk_bf16_f32 v12, v12, v13
    v_cvt_pk_bf16_f32 v13, v14, v15
    v_cvt_pk_bf16_f32 v14, v16, v17
    v_cvt_pk_bf16_f32 v15, v18, v19
    buffer_store_dwordx4 v[12:15], v0, s[8:11], s35 offen offset:1024 sc1
    s_nop 1
    s_add_u32 s35, s35, 131072
    v_readlane_b32 s40, v5, 2
    v_readlane_b32 s36, v4, 2
    s_nop 0
    v_mov_b32 v6, s40
    ds_read_b128 v[16:19], v2 offset:4096
    s_waitcnt lgkmcnt(0)
    v_lshlrev_b32 v12, 16, v16
    v_and_b32 v13, s42, v16
    v_lshlrev_b32 v14, 16, v17
    v_and_b32 v15, s42, v17
    v_lshlrev_b32 v16, 16, v18
    v_and_b32 v17, s42, v18
    v_lshlrev_b32 v18, 16, v19
    v_and_b32 v19, s42, v19
    v_pk_fma_f32 v[12:13], v[12:13], s[36:37], v[6:7] op_sel_hi:[1,0,0]
    v_pk_fma_f32 v[14:15], v[14:15], s[36:37], v[6:7] op_sel_hi:[1,0,0]
    v_pk_fma_f32 v[16:17], v[16:17], s[36:37], v[6:7] op_sel_hi:[1,0,0]
    v_pk_fma_f32 v[18:19], v[18:19], s[36:37], v[6:7] op_sel_hi:[1,0,0]
    v_cvt_pk_bf16_f32 v12, v12, v13
    v_cvt_pk_bf16_f32 v13, v14, v15
    v_cvt_pk_bf16_f32 v14, v16, v17
    v_cvt_pk_bf16_f32 v15, v18, v19
    buffer_store_dwordx4 v[12:15], v0, s[8:11], s35 offen sc1
    s_nop 1
    ds_read_b128 v[16:19], v2 offset:5120
    s_waitcnt lgkmcnt(0)
    v_lshlrev_b32 v12, 16, v16
    v_and_b32 v13, s42, v16
    v_lshlrev_b32 v14, 16, v17
    v_and_b32 v15, s42, v17
    v_lshlrev_b32 v16, 16, v18
    v_and_b32 v17, s42, v18
    v_lshlrev_b32 v18, 16, v19
    v_and_b32 v19, s42, v19
    v_pk_fma_f32 v[12:13], v[12:13], s[36:37], v[6:7] op_sel_hi:[1,0,0]
    v_pk_fma_f32 v[14:15], v[14:15], s[36:37], v[6:7] op_sel_hi:[1,0,0]
    v_pk_fma_f32 v[16:17], v[16:17], s[36:37], v[6:7] op_sel_hi:[1,0,0]
    v_pk_fma_f32 v[18:19], v[18:19], s[36:37], v[6:7] op_sel_hi:[1,0,0]
    v_cvt_pk_bf16_f32 v12, v12, v13
    v_cvt_pk_bf16_f32 v13, v14, v15
    v_cvt_pk_bf16_f32 v14, v16, v17
    v_cvt_pk_bf16_f32 v15, v18, v19
    buffer_store_dwordx4 v[12:15], v0, s[8:11], s35 offen offset:1024 sc1
    s_nop 1
    s_add_u32 s35, s35, 131072
    v_readlane_b32 s40, v5, 3
    v_readlane_b32 s38, v4, 3
    s_nop 0
    v_mov_b32 v7, s40
    ds_read_b128 v[16:19], v2 offset:6144
    s_waitcnt lgkmcnt(0)
    v_lshlrev_b32 v12, 16, v16
    v_and_b32 v13, s42, v16
    v_lshlrev_b32 v14, 16, v17
    v_and_b32 v15, s42, v17
    v_lshlrev_b32 v16, 16, v18
    v_and_b32 v17, s42, v18
    v_lshlrev_b32 v18, 16, v19
    v_and_b32 v19, s42, v19
    v_pk_fma_f32 v[12:13], v[12:13], s[38:39], v[6:7] op_sel:[0,0,1] op_sel_hi:[1,0,1]
    v_pk_fma_f32 v[14:15], v[14:15], s[38:39], v[6:7] op_sel:[0,0,1] op_sel_hi:[1,0,1]
    v_pk_fma_f32 v[16:17], v[16:17], s[38:39], v[6:7] op_sel:[0,0,1] op_sel_hi:[1,0,1]
    v_pk_fma_f32 v[18:19], v[18:19], s[38:39], v[6:7] op_sel:[0,0,1] op_sel_hi:[1,0,1]
    v_cvt_pk_bf16_f32 v12, v12, v13
    v_cvt_pk_bf16_f32 v13, v14, v15
    v_cvt_pk_bf16_f32 v14, v16, v17
    v_cvt_pk_bf16_f32 v15, v18, v19
    buffer_store_dwordx4 v[12:15], v0, s[8:11], s35 offen sc1
    s_nop 1
    ds_read_b128 v[16:19], v2 offset:7168
    s_waitcnt lgkmcnt(0)
    v_lshlrev_b32 v12, 16, v16
    v_and_b32 v13, s42, v16
    v_lshlrev_b32 v14, 16, v17
    v_and_b32 v15, s42, v17
    v_lshlrev_b32 v16, 16, v18
    v_and_b32 v17, s42, v18
    v_lshlrev_b32 v18, 16, v19
    v_and_b32 v19, s42, v19
    v_pk_fma_f32 v[12:13], v[12:13], s[38:39], v[6:7] op_sel:[0,0,1] op_sel_hi:[1,0,1]
    v_pk_fma_f32 v[14:15], v[14:15], s[38:39], v[6:7] op_sel:[0,0,1] op_sel_hi:[1,0,1]
    v_pk_fma_f32 v[16:17], v[16:17], s[38:39], v[6:7] op_sel:[0,0,1] op_sel_hi:[1,0,1]
    v_pk_fma_f32 v[18:19], v[18:19], s[38:39], v[6:7] op_sel:[0,0,1] op_sel_hi:[1,0,1]
    v_cvt_pk_bf16_f32 v12, v12, v13
    v_cvt_pk_bf16_f32 v13, v14, v15
    v_cvt_pk_bf16_f32 v14, v16, v17
    v_cvt_pk_bf16_f32 v15, v18, v19
    buffer_store_dwordx4 v[12:15], v0, s[8:11], s35 offen offset:1024 sc1
    s_nop 1
    s_add_u32 s35, s35, 131072
    v_readlane_b32 s40, v5, 4
    v_readlane_b32 s36, v4, 4
    s_nop 0
    v_mov_b32 v6, s40
    ds_read_b128 v[16:19], v2 offset:8192
    s_waitcnt lgkmcnt(0)
    v_lshlrev_b32 v12, 16, v16
    v_and_b32 v13, s42, v16
    v_lshlrev_b32 v14, 16, v17
    v_and_b32 v15, s42, v17
    v_lshlrev_b32 v16, 16, v18
    v_and_b32 v17, s42, v18
    v_lshlrev_b32 v18, 16, v19
    v_and_b32 v19, s42, v19
    v_pk_fma_f32 v[12:13], v[12:13], s[36:37], v[6:7] op_sel_hi:[1,0,0]
    v_pk_fma_f32 v[14:15], v[14:15], s[36:37], v[6:7] op_sel_hi:[1,0,0]
    v_pk_fma_f32 v[16:17], v[16:17], s[36:37], v[6:7] op_sel_hi:[1,0,0]
    v_pk_fma_f32 v[18:19], v[18:19], s[36:37], v[6:7] op_sel_hi:[1,0,0]
    v_cvt_pk_bf16_f32 v12, v12, v13
    v_cvt_pk_bf16_f32 v13, v14, v15
    v_cvt_pk_bf16_f32 v14, v16, v17
    v_cvt_pk_bf16_f32 v15, v18, v19
    buffer_store_dwordx4 v[12:15], v0, s[8:11], s35 offen sc1
    s_nop 1
    ds_read_b128 v[16:19], v2 offset:9216
    s_waitcnt lgkmcnt(0)
    v_lshlrev_b32 v12, 16, v16
    v_and_b32 v13, s42, v16
    v_lshlrev_b32 v14, 16, v17
    v_and_b32 v15, s42, v17
    v_lshlrev_b32 v16, 16, v18
    v_and_b32 v17, s42, v18
    v_lshlrev_b32 v18, 16, v19
    v_and_b32 v19, s42, v19
    v_pk_fma_f32 v[12:13], v[12:13], s[36:37], v[6:7] op_sel_hi:[1,0,0]
    v_pk_fma_f32 v[14:15], v[14:15], s[36:37], v[6:7] op_sel_hi:[1,0,0]
    v_pk_fma_f32 v[16:17], v[16:17], s[36:37], v[6:7] op_sel_hi:[1,0,0]
    v_pk_fma_f32 v[18:19], v[18:19], s[36:37], v[6:7] op_sel_hi:[1,0,0]
    v_cvt_pk_bf16_f32 v12, v12, v13
    v_cvt_pk_bf16_f32 v13, v14, v15
    v_cvt_pk_bf16_f32 v14, v16, v17
    v_cvt_pk_bf16_f32 v15, v18, v19
    buffer_store_dwordx4 v[12:15], v0, s[8:11], s35 offen offset:1024 sc1
    s_nop 1
    s_add_u32 s35, s35, 131072
    v_readlane_b32 s40, v5, 5
    v_readlane_b32 s38, v4, 5
    s_nop 0
    v_mov_b32 v7, s40
    ds_read_b128 v[16:19], v2 offset:10240
    s_waitcnt lgkmcnt(0)
    v_lshlrev_b32 v12, 16, v16
    v_and_b32 v13, s42, v16
    v_lshlrev_b32 v14, 16, v17
    v_and_b32 v15, s42, v17
    v_lshlrev_b32 v16, 16, v18
    v_and_b32 v17, s42, v18
    v_lshlrev_b32 v18, 16, v19
    v_and_b32 v19, s42, v19
    v_pk_fma_f32 v[12:13], v[12:13], s[38:39], v[6:7] op_sel:[0,0,1] op_sel_hi:[1,0,1]
    v_pk_fma_f32 v[14:15], v[14:15], s[38:39], v[6:7] op_sel:[0,0,1] op_sel_hi:[1,0,1]
    v_pk_fma_f32 v[16:17], v[16:17], s[38:39], v[6:7] op_sel:[0,0,1] op_sel_hi:[1,0,1]
    v_pk_fma_f32 v[18:19], v[18:19], s[38:39], v[6:7] op_sel:[0,0,1] op_sel_hi:[1,0,1]
    v_cvt_pk_bf16_f32 v12, v12, v13
    v_cvt_pk_bf16_f32 v13, v14, v15
    v_cvt_pk_bf16_f32 v14, v16, v17
    v_cvt_pk_bf16_f32 v15, v18, v19
    buffer_store_dwordx4 v[12:15], v0, s[8:11], s35 offen sc1
    s_nop 1
    ds_read_b128 v[16:19], v2 offset:11264
    s_waitcnt lgkmcnt(0)
    v_lshlrev_b32 v12, 16, v16
    v_and_b32 v13, s42, v16
    v_lshlrev_b32 v14, 16, v17
    v_and_b32 v15, s42, v17
    v_lshlrev_b32 v16, 16, v18
    v_and_b32 v17, s42, v18
    v_lshlrev_b32 v18, 16, v19
    v_and_b32 v19, s42, v19
    v_pk_fma_f32 v[12:13], v[12:13], s[38:39], v[6:7] op_sel:[0,0,1] op_sel_hi:[1,0,1]
    v_pk_fma_f32 v[14:15], v[14:15], s[38:39], v[6:7] op_sel:[0,0,1] op_sel_hi:[1,0,1]
    v_pk_fma_f32 v[16:17], v[16:17], s[38:39], v[6:7] op_sel:[0,0,1] op_sel_hi:[1,0,1]
    v_pk_fma_f32 v[18:19], v[18:19], s[38:39], v[6:7] op_sel:[0,0,1] op_sel_hi:[1,0,1]
    v_cvt_pk_bf16_f32 v12, v12, v13
    v_cvt_pk_bf16_f32 v13, v14, v15
    v_cvt_pk_bf16_f32 v14, v16, v17
    v_cvt_pk_bf16_f32 v15, v18, v19
    buffer_store_dwordx4 v[12:15], v0, s[8:11], s35 offen offset:1024 sc1
    s_nop 1
    s_add_u32 s35, s35, 131072
    v_readlane_b32 s40, v5, 6
    v_readlane_b32 s36, v4, 6
    s_nop 0
    v_mov_b32 v6, s40
    ds_read_b128 v[16:19], v2 offset:12288
    s_waitcnt lgkmcnt(0)
    v_lshlrev_b32 v12, 16, v16
    v_and_b32 v13, s42, v16
    v_lshlrev_b32 v14, 16, v17
    v_and_b32 v15, s42, v17
    v_lshlrev_b32 v16, 16, v18
    v_and_b32 v17, s42, v18
    v_lshlrev_b32 v18, 16, v19
    v_and_b32 v19, s42, v19
    v_pk_fma_f32 v[12:13], v[12:13], s[36:37], v[6:7] op_sel_hi:[1,0,0]
    v_pk_fma_f32 v[14:15], v[14:15], s[36:37], v[6:7] op_sel_hi:[1,0,0]
    v_pk_fma_f32 v[16:17], v[16:17], s[36:37], v[6:7] op_sel_hi:[1,0,0]
    v_pk_fma_f32 v[18:19], v[18:19], s[36:37], v[6:7] op_sel_hi:[1,0,0]
    v_cvt_pk_bf16_f32 v12, v12, v13
    v_cvt_pk_bf16_f32 v13, v14, v15
    v_cvt_pk_bf16_f32 v14, v16, v17
    v_cvt_pk_bf16_f32 v15, v18, v19
    buffer_store_dwordx4 v[12:15], v0, s[8:11], s35 offen sc1
    s_nop 1
    ds_read_b128 v[16:19], v2 offset:13312
    s_waitcnt lgkmcnt(0)
    v_lshlrev_b32 v12, 16, v16
    v_and_b32 v13, s42, v16
    v_lshlrev_b32 v14, 16, v17
    v_and_b32 v15, s42, v17
    v_lshlrev_b32 v16, 16, v18
    v_and_b32 v17, s42, v18
    v_lshlrev_b32 v18, 16, v19
    v_and_b32 v19, s42, v19
    v_pk_fma_f32 v[12:13], v[12:13], s[36:37], v[6:7] op_sel_hi:[1,0,0]
    v_pk_fma_f32 v[14:15], v[14:15], s[36:37], v[6:7] op_sel_hi:[1,0,0]
    v_pk_fma_f32 v[16:17], v[16:17], s[36:37], v[6:7] op_sel_hi:[1,0,0]
    v_pk_fma_f32 v[18:19], v[18:19], s[36:37], v[6:7] op_sel_hi:[1,0,0]
    v_cvt_pk_bf16_f32 v12, v12, v13
    v_cvt_pk_bf16_f32 v13, v14, v15
    v_cvt_pk_bf16_f32 v14, v16, v17
    v_cvt_pk_bf16_f32 v15, v18, v19
    buffer_store_dwordx4 v[12:15], v0, s[8:11], s35 offen offset:1024 sc1
    s_nop 1
    s_add_u32 s35, s35, 131072
    v_readlane_b32 s40, v5, 7
    v_readlane_b32 s38, v4, 7
    s_nop 0
    v_mov_b32 v7, s40
    ds_read_b128 v[16:19], v2 offset:14336
    s_waitcnt lgkmcnt(0)
    v_lshlrev_b32 v12, 16, v16
    v_and_b32 v13, s42, v16
    v_lshlrev_b32 v14, 16, v17
    v_and_b32 v15, s42, v17
    v_lshlrev_b32 v16, 16, v18
    v_and_b32 v17, s42, v18
    v_lshlrev_b32 v18, 16, v19
    v_and_b32 v19, s42, v19
    v_pk_fma_f32 v[12:13], v[12:13], s[38:39], v[6:7] op_sel:[0,0,1] op_sel_hi:[1,0,1]
    v_pk_fma_f32 v[14:15], v[14:15], s[38:39], v[6:7] op_sel:[0,0,1] op_sel_hi:[1,0,1]
    v_pk_fma_f32 v[16:17], v[16:17], s[38:39], v[6:7] op_sel:[0,0,1] op_sel_hi:[1,0,1]
    v_pk_fma_f32 v[18:19], v[18:19], s[38:39], v[6:7] op_sel:[0,0,1] op_sel_hi:[1,0,1]
    v_cvt_pk_bf16_f32 v12, v12, v13
    v_cvt_pk_bf16_f32 v13, v14, v15
    v_cvt_pk_bf16_f32 v14, v16, v17
    v_cvt_pk_bf16_f32 v15, v18, v19
    buffer_store_dwordx4 v[12:15], v0, s[8:11], s35 offen sc1
    s_nop 1
    ds_read_b128 v[16:19], v2 offset:15360
    s_waitcnt lgkmcnt(0)
    v_lshlrev_b32 v12, 16, v16
    v_and_b32 v13, s42, v16
    v_lshlrev_b32 v14, 16, v17
    v_and_b32 v15, s42, v17
    v_lshlrev_b32 v16, 16, v18
    v_and_b32 v17, s42, v18
    v_lshlrev_b32 v18, 16, v19
    v_and_b32 v19, s42, v19
    v_pk_fma_f32 v[12:13], v[12:13], s[38:39], v[6:7] op_sel:[0,0,1] op_sel_hi:[1,0,1]
    v_pk_fma_f32 v[14:15], v[14:15], s[38:39], v[6:7] op_sel:[0,0,1] op_sel_hi:[1,0,1]
    v_pk_fma_f32 v[16:17], v[16:17], s[38:39], v[6:7] op_sel:[0,0,1] op_sel_hi:[1,0,1]
    v_pk_fma_f32 v[18:19], v[18:19], s[38:39], v[6:7] op_sel:[0,0,1] op_sel_hi:[1,0,1]
    v_cvt_pk_bf16_f32 v12, v12, v13
    v_cvt_pk_bf16_f32 v13, v14, v15
    v_cvt_pk_bf16_f32 v14, v16, v17
    v_cvt_pk_bf16_f32 v15, v18, v19
    buffer_store_dwordx4 v[12:15], v0, s[8:11], s35 offen offset:1024 sc1
    s_nop 1
    s_add_u32 s35, s35, 131072
    v_readlane_b32 s40, v5, 8
    v_readlane_b32 s36, v4, 8
    s_nop 0
    v_mov_b32 v6, s40
    ds_read_b128 v[16:19], v2 offset:16384
    s_waitcnt lgkmcnt(0)
    v_lshlrev_b32 v12, 16, v16
    v_and_b32 v13, s42, v16
    v_lshlrev_b32 v14, 16, v17
    v_and_b32 v15, s42, v17
    v_lshlrev_b32 v16, 16, v18
    v_and_b32 v17, s42, v18
    v_lshlrev_b32 v18, 16, v19
    v_and_b32 v19, s42, v19
    v_pk_fma_f32 v[12:13], v[12:13], s[36:37], v[6:7] op_sel_hi:[1,0,0]
    v_pk_fma_f32 v[14:15], v[14:15], s[36:37], v[6:7] op_sel_hi:[1,0,0]
    v_pk_fma_f32 v[16:17], v[16:17], s[36:37], v[6:7] op_sel_hi:[1,0,0]
    v_pk_fma_f32 v[18:19], v[18:19], s[36:37], v[6:7] op_sel_hi:[1,0,0]
    v_cvt_pk_bf16_f32 v12, v12, v13
    v_cvt_pk_bf16_f32 v13, v14, v15
    v_cvt_pk_bf16_f32 v14, v16, v17
    v_cvt_pk_bf16_f32 v15, v18, v19
    buffer_store_dwordx4 v[12:15], v0, s[8:11], s35 offen sc1
    s_nop 1
    ds_read_b128 v[16:19], v2 offset:17408
    s_waitcnt lgkmcnt(0)
    v_lshlrev_b32 v12, 16, v16
    v_and_b32 v13, s42, v16
    v_lshlrev_b32 v14, 16, v17
    v_and_b32 v15, s42, v17
    v_lshlrev_b32 v16, 16, v18
    v_and_b32 v17, s42, v18
    v_lshlrev_b32 v18, 16, v19
    v_and_b32 v19, s42, v19
    v_pk_fma_f32 v[12:13], v[12:13], s[36:37], v[6:7] op_sel_hi:[1,0,0]
    v_pk_fma_f32 v[14:15], v[14:15], s[36:37], v[6:7] op_sel_hi:[1,0,0]
    v_pk_fma_f32 v[16:17], v[16:17], s[36:37], v[6:7] op_sel_hi:[1,0,0]
    v_pk_fma_f32 v[18:19], v[18:19], s[36:37], v[6:7] op_sel_hi:[1,0,0]
    v_cvt_pk_bf16_f32 v12, v12, v13
    v_cvt_pk_bf16_f32 v13, v14, v15
    v_cvt_pk_bf16_f32 v14, v16, v17
    v_cvt_pk_bf16_f32 v15, v18, v19
    buffer_store_dwordx4 v[12:15], v0, s[8:11], s35 offen offset:1024 sc1
    s_nop 1
    s_add_u32 s35, s35, 131072
    v_readlane_b32 s40, v5, 9
    v_readlane_b32 s38, v4, 9
    s_nop 0
    v_mov_b32 v7, s40
    v_lshlrev_b32 v12, 16, v20
    v_and_b32 v13, s42, v20
    v_lshlrev_b32 v14, 16, v21
    v_and_b32 v15, s42, v21
    v_lshlrev_b32 v16, 16, v22
    v_and_b32 v17, s42, v22
    v_lshlrev_b32 v18, 16, v23
    v_and_b32 v19, s42, v23
    v_pk_fma_f32 v[12:13], v[12:13], s[38:39], v[6:7] op_sel:[0,0,1] op_sel_hi:[1,0,1]
    v_pk_fma_f32 v[14:15], v[14:15], s[38:39], v[6:7] op_sel:[0,0,1] op_sel_hi:[1,0,1]
    v_pk_fma_f32 v[16:17], v[16:17], s[38:39], v[6:7] op_sel:[0,0,1] op_sel_hi:[1,0,1]
    v_pk_fma_f32 v[18:19], v[18:19], s[38:39], v[6:7] op_sel:[0,0,1] op_sel_hi:[1,0,1]
    v_cvt_pk_bf16_f32 v20, v12, v13
    v_cvt_pk_bf16_f32 v21, v14, v15
    v_cvt_pk_bf16_f32 v22, v16, v17
    v_cvt_pk_bf16_f32 v23, v18, v19
    buffer_store_dwordx4 v[20:23], v0, s[8:11], s35 offen sc1
    v_lshlrev_b32 v12, 16, v24
    v_and_b32 v13, s42, v24
    v_lshlrev_b32 v14, 16, v25
    v_and_b32 v15, s42, v25
    v_lshlrev_b32 v16, 16, v26
    v_and_b32 v17, s42, v26
    v_lshlrev_b32 v18, 16, v27
    v_and_b32 v19, s42, v27
    v_pk_fma_f32 v[12:13], v[12:13], s[38:39], v[6:7] op_sel:[0,0,1] op_sel_hi:[1,0,1]
    v_pk_fma_f32 v[14:15], v[14:15], s[38:39], v[6:7] op_sel:[0,0,1] op_sel_hi:[1,0,1]
    v_pk_fma_f32 v[16:17], v[16:17], s[38:39], v[6:7] op_sel:[0,0,1] op_sel_hi:[1,0,1]
    v_pk_fma_f32 v[18:19], v[18:19], s[38:39], v[6:7] op_sel:[0,0,1] op_sel_hi:[1,0,1]
    v_cvt_pk_bf16_f32 v24, v12, v13
    v_cvt_pk_bf16_f32 v25, v14, v15
    v_cvt_pk_bf16_f32 v26, v16, v17
    v_cvt_pk_bf16_f32 v27, v18, v19
    buffer_store_dwordx4 v[24:27], v0, s[8:11], s35 offen offset:1024 sc1
    s_add_u32 s35, s35, 131072
    v_readlane_b32 s40, v5, 10
    v_readlane_b32 s36, v4, 10
    s_nop 0
    v_mov_b32 v6, s40
    v_lshlrev_b32 v12, 16, v28
    v_and_b32 v13, s42, v28
    v_lshlrev_b32 v14, 16, v29
    v_and_b32 v15, s42, v29
    v_lshlrev_b32 v16, 16, v30
    v_and_b32 v17, s42, v30
    v_lshlrev_b32 v18, 16, v31
    v_and_b32 v19, s42, v31
    v_pk_fma_f32 v[12:13], v[12:13], s[36:37], v[6:7] op_sel_hi:[1,0,0]
    v_pk_fma_f32 v[14:15], v[14:15], s[36:37], v[6:7] op_sel_hi:[1,0,0]
    v_pk_fma_f32 v[16:17], v[16:17], s[36:37], v[6:7] op_sel_hi:[1,0,0]
    v_pk_fma_f32 v[18:19], v[18:19], s[36:37], v[6:7] op_sel_hi:[1,0,0]
    v_cvt_pk_bf16_f32 v28, v12, v13
    v_cvt_pk_bf16_f32 v29, v14, v15
    v_cvt_pk_bf16_f32 v30, v16, v17
    v_cvt_pk_bf16_f32 v31, v18, v19
    buffer_store_dwordx4 v[28:31], v0, s[8:11], s35 offen sc1
    s_add_u32 s55, s55, 128
    s_mov_b64 exec, 0xff
    v_subrev_u32 v16, s43, v2
    buffer_load_dwordx4 v[8:11], v16, s[12:15], s55 offen sc1
    s_mov_b64 exec, -1
    v_lshlrev_b32 v12, 16, v32
    v_and_b32 v13, s42, v32
    v_lshlrev_b32 v14, 16, v33
    v_and_b32 v15, s42, v33
    v_lshlrev_b32 v16, 16, v34
    v_and_b32 v17, s42, v34
    v_lshlrev_b32 v18, 16, v35
    v_and_b32 v19, s42, v35
    v_pk_fma_f32 v[12:13], v[12:13], s[36:37], v[6:7] op_sel_hi:[1,0,0]
    v_pk_fma_f32 v[14:15], v[14:15], s[36:37], v[6:7] op_sel_hi:[1,0,0]
    v_pk_fma_f32 v[16:17], v[16:17], s[36:37], v[6:7] op_sel_hi:[1,0,0]
    v_pk_fma_f32 v[18:19], v[18:19], s[36:37], v[6:7] op_sel_hi:[1,0,0]
    v_cvt_pk_bf16_f32 v32, v12, v13
    v_cvt_pk_bf16_f32 v33, v14, v15
    v_cvt_pk_bf16_f32 v34, v16, v17
    v_cvt_pk_bf16_f32 v35, v18, v19
    buffer_store_dwordx4 v[32:35], v0, s[8:11], s35 offen offset:1024 sc1
    s_add_u32 s35, s35, 131072
    v_readlane_b32 s40, v5, 11
    v_readlane_b32 s38, v4, 11
    s_nop 0
    v_mov_b32 v7, s40
    v_lshlrev_b32 v12, 16, v36
    v_and_b32 v13, s42, v36
    v_lshlrev_b32 v14, 16, v37
    v_and_b32 v15, s42, v37
    v_lshlrev_b32 v16, 16, v38
    v_and_b32 v17, s42, v38
    v_lshlrev_b32 v18, 16, v39
    v_and_b32 v19, s42, v39
    v_pk_fma_f32 v[12:13], v[12:13], s[38:39], v[6:7] op_sel:[0,0,1] op_sel_hi:[1,0,1]
    v_pk_fma_f32 v[14:15], v[14:15], s[38:39], v[6:7] op_sel:[0,0,1] op_sel_hi:[1,0,1]
    v_pk_fma_f32 v[16:17], v[16:17], s[38:39], v[6:7] op_sel:[0,0,1] op_sel_hi:[1,0,1]
    v_pk_fma_f32 v[18:19], v[18:19], s[38:39], v[6:7] op_sel:[0,0,1] op_sel_hi:[1,0,1]
    v_cvt_pk_bf16_f32 v36, v12, v13
    v_cvt_pk_bf16_f32 v37, v14, v15
    v_cvt_pk_bf16_f32 v38, v16, v17
    v_cvt_pk_bf16_f32 v39, v18, v19
    buffer_store_dwordx4 v[36:39], v0, s[8:11], s35 offen sc1
    v_lshlrev_b32 v12, 16, v40
    v_and_b32 v13, s42, v40
    v_lshlrev_b32 v14, 16, v41
    v_and_b32 v15, s42, v41
    v_lshlrev_b32 v16, 16, v42
    v_and_b32 v17, s42, v42
    v_lshlrev_b32 v18, 16, v43
    v_and_b32 v19, s42, v43
    v_pk_fma_f32 v[12:13], v[12:13], s[38:39], v[6:7] op_sel:[0,0,1] op_sel_hi:[1,0,1]
    v_pk_fma_f32 v[14:15], v[14:15], s[38:39], v[6:7] op_sel:[0,0,1] op_sel_hi:[1,0,1]
    v_pk_fma_f32 v[16:17], v[16:17], s[38:39], v[6:7] op_sel:[0,0,1] op_sel_hi:[1,0,1]
    v_pk_fma_f32 v[18:19], v[18:19], s[38:39], v[6:7] op_sel:[0,0,1] op_sel_hi:[1,0,1]
    v_cvt_pk_bf16_f32 v40, v12, v13
    v_cvt_pk_bf16_f32 v41, v14, v15
    v_cvt_pk_bf16_f32 v42, v16, v17
    v_cvt_pk_bf16_f32 v43, v18, v19
    buffer_store_dwordx4 v[40:43], v0, s[8:11], s35 offen offset:1024 sc1
    s_add_u32 s35, s35, 131072
    v_readlane_b32 s40, v5, 12
    v_readlane_b32 s36, v4, 12
    s_nop 0
    v_mov_b32 v6, s40
    v_lshlrev_b32 v12, 16, v44
    v_and_b32 v13, s42, v44
    v_lshlrev_b32 v14, 16, v45
    v_and_b32 v15, s42, v45
    v_lshlrev_b32 v16, 16, v46
    v_and_b32 v17, s42, v46
    v_lshlrev_b32 v18, 16, v47
    v_and_b32 v19, s42, v47
    v_pk_fma_f32 v[12:13], v[12:13], s[36:37], v[6:7] op_sel_hi:[1,0,0]
    v_pk_fma_f32 v[14:15], v[14:15], s[36:37], v[6:7] op_sel_hi:[1,0,0]
    v_pk_fma_f32 v[16:17], v[16:17], s[36:37], v[6:7] op_sel_hi:[1,0,0]
    v_pk_fma_f32 v[18:19], v[18:19], s[36:37], v[6:7] op_sel_hi:[1,0,0]
    v_cvt_pk_bf16_f32 v44, v12, v13
    v_cvt_pk_bf16_f32 v45, v14, v15
    v_cvt_pk_bf16_f32 v46, v16, v17
    v_cvt_pk_bf16_f32 v47, v18, v19
    buffer_store_dwordx4 v[44:47], v0, s[8:11], s35 offen sc1
    v_lshlrev_b32 v12, 16, v48
    v_and_b32 v13, s42, v48
    v_lshlrev_b32 v14, 16, v49
    v_and_b32 v15, s42, v49
    v_lshlrev_b32 v16, 16, v50
    v_and_b32 v17, s42, v50
    v_lshlrev_b32 v18, 16, v51
    v_and_b32 v19, s42, v51
    v_pk_fma_f32 v[12:13], v[12:13], s[36:37], v[6:7] op_sel_hi:[1,0,0]
    v_pk_fma_f32 v[14:15], v[14:15], s[36:37], v[6:7] op_sel_hi:[1,0,0]
    v_pk_fma_f32 v[16:17], v[16:17], s[36:37], v[6:7] op_sel_hi:[1,0,0]
    v_pk_fma_f32 v[18:19], v[18:19], s[36:37], v[6:7] op_sel_hi:[1,0,0]
    v_cvt_pk_bf16_f32 v48, v12, v13
    v_cvt_pk_bf16_f32 v49, v14, v15
    v_cvt_pk_bf16_f32 v50, v16, v17
    v_cvt_pk_bf16_f32 v51, v18, v19
    buffer_store_dwordx4 v[48:51], v0, s[8:11], s35 offen offset:1024 sc1
    s_add_u32 s35, s35, 131072
    v_readlane_b32 s40, v5, 13
    v_readlane_b32 s38, v4, 13
    s_nop 0
    v_mov_b32 v7, s40
    v_lshlrev_b32 v12, 16, v52
    v_and_b32 v13, s42, v52
    v_lshlrev_b32 v14, 16, v53
    v_and_b32 v15, s42, v53
    v_lshlrev_b32 v16, 16, v54
    v_and_b32 v17, s42, v54
    v_lshlrev_b32 v18, 16, v55
    v_and_b32 v19, s42, v55
    v_pk_fma_f32 v[12:13], v[12:13], s[38:39], v[6:7] op_sel:[0,0,1] op_sel_hi:[1,0,1]
    v_pk_fma_f32 v[14:15], v[14:15], s[38:39], v[6:7] op_sel:[0,0,1] op_sel_hi:[1,0,1]
    v_pk_fma_f32 v[16:17], v[16:17], s[38:39], v[6:7] op_sel:[0,0,1] op_sel_hi:[1,0,1]
    v_pk_fma_f32 v[18:19], v[18:19], s[38:39], v[6:7] op_sel:[0,0,1] op_sel_hi:[1,0,1]
    v_cvt_pk_bf16_f32 v52, v12, v13
    v_cvt_pk_bf16_f32 v53, v14, v15
    v_cvt_pk_bf16_f32 v54, v16, v17
    v_cvt_pk_bf16_f32 v55, v18, v19
    buffer_store_dwordx4 v[52:55], v0, s[8:11], s35 offen sc1
    v_lshlrev_b32 v12, 16, v56
    v_and_b32 v13, s42, v56
    v_lshlrev_b32 v14, 16, v57
    v_and_b32 v15, s42, v57
    v_lshlrev_b32 v16, 16, v58
    v_and_b32 v17, s42, v58
    v_lshlrev_b32 v18, 16, v59
    v_and_b32 v19, s42, v59
    v_pk_fma_f32 v[12:13], v[12:13], s[38:39], v[6:7] op_sel:[0,0,1] op_sel_hi:[1,0,1]
    v_pk_fma_f32 v[14:15], v[14:15], s[38:39], v[6:7] op_sel:[0,0,1] op_sel_hi:[1,0,1]
    v_pk_fma_f32 v[16:17], v[16:17], s[38:39], v[6:7] op_sel:[0,0,1] op_sel_hi:[1,0,1]
    v_pk_fma_f32 v[18:19], v[18:19], s[38:39], v[6:7] op_sel:[0,0,1] op_sel_hi:[1,0,1]
    v_cvt_pk_bf16_f32 v56, v12, v13
    v_cvt_pk_bf16_f32 v57, v14, v15
    v_cvt_pk_bf16_f32 v58, v16, v17
    v_cvt_pk_bf16_f32 v59, v18, v19
    buffer_store_dwordx4 v[56:59], v0, s[8:11], s35 offen offset:1024 sc1
    s_add_u32 s35, s35, 131072
    v_readlane_b32 s40, v5, 14
    v_readlane_b32 s36, v4, 14
    s_nop 0
    v_mov_b32 v6, s40
    v_lshlrev_b32 v12, 16, v60
    v_and_b32 v13, s42, v60
    v_lshlrev_b32 v14, 16, v61
    v_and_b32 v15, s42, v61
    v_lshlrev_b32 v16, 16, v62
    v_and_b32 v17, s42, v62
    v_lshlrev_b32 v18, 16, v63
    v_and_b32 v19, s42, v63
    v_pk_fma_f32 v[12:13], v[12:13], s[36:37], v[6:7] op_sel_hi:[1,0,0]
    v_pk_fma_f32 v[14:15], v[14:15], s[36:37], v[6:7] op_sel_hi:[1,0,0]
    v_pk_fma_f32 v[16:17], v[16:17], s[36:37], v[6:7] op_sel_hi:[1,0,0]
    v_pk_fma_f32 v[18:19], v[18:19], s[36:37], v[6:7] op_sel_hi:[1,0,0]
    v_cvt_pk_bf16_f32 v60, v12, v13
    v_cvt_pk_bf16_f32 v61, v14, v15
    v_cvt_pk_bf16_f32 v62, v16, v17
    v_cvt_pk_bf16_f32 v63, v18, v19
    buffer_store_dwordx4 v[60:63], v0, s[8:11], s35 offen sc1
    v_lshlrev_b32 v12, 16, v64
    v_and_b32 v13, s42, v64
    v_lshlrev_b32 v14, 16, v65
    v_and_b32 v15, s42, v65
    v_lshlrev_b32 v16, 16, v66
    v_and_b32 v17, s42, v66
    v_lshlrev_b32 v18, 16, v67
    v_and_b32 v19, s42, v67
    v_pk_fma_f32 v[12:13], v[12:13], s[36:37], v[6:7] op_sel_hi:[1,0,0]
    v_pk_fma_f32 v[14:15], v[14:15], s[36:37], v[6:7] op_sel_hi:[1,0,0]
    v_pk_fma_f32 v[16:17], v[16:17], s[36:37], v[6:7] op_sel_hi:[1,0,0]
    v_pk_fma_f32 v[18:19], v[18:19], s[36:37], v[6:7] op_sel_hi:[1,0,0]
    v_cvt_pk_bf16_f32 v64, v12, v13
    v_cvt_pk_bf16_f32 v65, v14, v15
    v_cvt_pk_bf16_f32 v66, v16, v17
    v_cvt_pk_bf16_f32 v67, v18, v19
    buffer_store_dwordx4 v[64:67], v0, s[8:11], s35 offen offset:1024 sc1
    s_add_u32 s35, s35, 131072
    v_readlane_b32 s40, v5, 15
    v_readlane_b32 s38, v4, 15
    s_nop 0
    v_mov_b32 v7, s40
    v_lshlrev_b32 v12, 16, v68
    v_and_b32 v13, s42, v68
    v_lshlrev_b32 v14, 16, v69
    v_and_b32 v15, s42, v69
    v_lshlrev_b32 v16, 16, v70
    v_and_b32 v17, s42, v70
    v_lshlrev_b32 v18, 16, v71
    v_and_b32 v19, s42, v71
    v_pk_fma_f32 v[12:13], v[12:13], s[38:39], v[6:7] op_sel:[0,0,1] op_sel_hi:[1,0,1]
    v_pk_fma_f32 v[14:15], v[14:15], s[38:39], v[6:7] op_sel:[0,0,1] op_sel_hi:[1,0,1]
    v_pk_fma_f32 v[16:17], v[16:17], s[38:39], v[6:7] op_sel:[0,0,1] op_sel_hi:[1,0,1]
    v_pk_fma_f32 v[18:19], v[18:19], s[38:39], v[6:7] op_sel:[0,0,1] op_sel_hi:[1,0,1]
    v_cvt_pk_bf16_f32 v68, v12, v13
    v_cvt_pk_bf16_f32 v69, v14, v15
    v_cvt_pk_bf16_f32 v70, v16, v17
    v_cvt_pk_bf16_f32 v71, v18, v19
    buffer_store_dwordx4 v[68:71], v0, s[8:11], s35 offen sc1
    v_lshlrev_b32 v12, 16, v72
    v_and_b32 v13, s42, v72
    v_lshlrev_b32 v14, 16, v73
    v_and_b32 v15, s42, v73
    v_lshlrev_b32 v16, 16, v74
    v_and_b32 v17, s42, v74
    v_lshlrev_b32 v18, 16, v75
    v_and_b32 v19, s42, v75
    v_pk_fma_f32 v[12:13], v[12:13], s[38:39], v[6:7] op_sel:[0,0,1] op_sel_hi:[1,0,1]
    v_pk_fma_f32 v[14:15], v[14:15], s[38:39], v[6:7] op_sel:[0,0,1] op_sel_hi:[1,0,1]
    v_pk_fma_f32 v[16:17], v[16:17], s[38:39], v[6:7] op_sel:[0,0,1] op_sel_hi:[1,0,1]
    v_pk_fma_f32 v[18:19], v[18:19], s[38:39], v[6:7] op_sel:[0,0,1] op_sel_hi:[1,0,1]
    v_cvt_pk_bf16_f32 v72, v12, v13
    v_cvt_pk_bf16_f32 v73, v14, v15
    v_cvt_pk_bf16_f32 v74, v16, v17
    v_cvt_pk_bf16_f32 v75, v18, v19
    buffer_store_dwordx4 v[72:75], v0, s[8:11], s35 offen offset:1024 sc1
    s_add_u32 s35, s35, 131072
    v_readlane_b32 s40, v5, 16
    v_readlane_b32 s36, v4, 16
    s_nop 0
    v_mov_b32 v6, s40
    v_lshlrev_b32 v12, 16, v76
    v_and_b32 v13, s42, v76
    v_lshlrev_b32 v14, 16, v77
    v_and_b32 v15, s42, v77
    v_lshlrev_b32 v16, 16, v78
    v_and_b32 v17, s42, v78
    v_lshlrev_b32 v18, 16, v79
    v_and_b32 v19, s42, v79
    v_pk_fma_f32 v[12:13], v[12:13], s[36:37], v[6:7] op_sel_hi:[1,0,0]
    v_pk_fma_f32 v[14:15], v[14:15], s[36:37], v[6:7] op_sel_hi:[1,0,0]
    v_pk_fma_f32 v[16:17], v[16:17], s[36:37], v[6:7] op_sel_hi:[1,0,0]
    v_pk_fma_f32 v[18:19], v[18:19], s[36:37], v[6:7] op_sel_hi:[1,0,0]
    v_cvt_pk_bf16_f32 v76, v12, v13
    v_cvt_pk_bf16_f32 v77, v14, v15
    v_cvt_pk_bf16_f32 v78, v16, v17
    v_cvt_pk_bf16_f32 v79, v18, v19
    buffer_store_dwordx4 v[76:79], v0, s[8:11], s35 offen sc1
    v_lshlrev_b32 v12, 16, v80
    v_and_b32 v13, s42, v80
    v_lshlrev_b32 v14, 16, v81
    v_and_b32 v15, s42, v81
    v_lshlrev_b32 v16, 16, v82
    v_and_b32 v17, s42, v82
    v_lshlrev_b32 v18, 16, v83
    v_and_b32 v19, s42, v83
    v_pk_fma_f32 v[12:13], v[12:13], s[36:37], v[6:7] op_sel_hi:[1,0,0]
    v_pk_fma_f32 v[14:15], v[14:15], s[36:37], v[6:7] op_sel_hi:[1,0,0]
    v_pk_fma_f32 v[16:17], v[16:17], s[36:37], v[6:7] op_sel_hi:[1,0,0]
    v_pk_fma_f32 v[18:19], v[18:19], s[36:37], v[6:7] op_sel_hi:[1,0,0]
    v_cvt_pk_bf16_f32 v80, v12, v13
    v_cvt_pk_bf16_f32 v81, v14, v15
    v_cvt_pk_bf16_f32 v82, v16, v17
    v_cvt_pk_bf16_f32 v83, v18, v19
    buffer_store_dwordx4 v[80:83], v0, s[8:11], s35 offen offset:1024 sc1
    s_add_u32 s35, s35, 131072
    v_readlane_b32 s40, v5, 17
    v_readlane_b32 s38, v4, 17
    s_nop 0
    v_mov_b32 v7, s40
    v_lshlrev_b32 v12, 16, v84
    v_and_b32 v13, s42, v84
    v_lshlrev_b32 v14, 16, v85
    v_and_b32 v15, s42, v85
    v_lshlrev_b32 v16, 16, v86
    v_and_b32 v17, s42, v86
    v_lshlrev_b32 v18, 16, v87
    v_and_b32 v19, s42, v87
    v_pk_fma_f32 v[12:13], v[12:13], s[38:39], v[6:7] op_sel:[0,0,1] op_sel_hi:[1,0,1]
    v_pk_fma_f32 v[14:15], v[14:15], s[38:39], v[6:7] op_sel:[0,0,1] op_sel_hi:[1,0,1]
    v_pk_fma_f32 v[16:17], v[16:17], s[38:39], v[6:7] op_sel:[0,0,1] op_sel_hi:[1,0,1]
    v_pk_fma_f32 v[18:19], v[18:19], s[38:39], v[6:7] op_sel:[0,0,1] op_sel_hi:[1,0,1]
    v_cvt_pk_bf16_f32 v84, v12, v13
    v_cvt_pk_bf16_f32 v85, v14, v15
    v_cvt_pk_bf16_f32 v86, v16, v17
    v_cvt_pk_bf16_f32 v87, v18, v19
    buffer_store_dwordx4 v[84:87], v0, s[8:11], s35 offen sc1
    v_lshlrev_b32 v12, 16, v88
    v_and_b32 v13, s42, v88
    v_lshlrev_b32 v14, 16, v89
    v_and_b32 v15, s42, v89
    v_lshlrev_b32 v16, 16, v90
    v_and_b32 v17, s42, v90
    v_lshlrev_b32 v18, 16, v91
    v_and_b32 v19, s42, v91
    v_pk_fma_f32 v[12:13], v[12:13], s[38:39], v[6:7] op_sel:[0,0,1] op_sel_hi:[1,0,1]
    v_pk_fma_f32 v[14:15], v[14:15], s[38:39], v[6:7] op_sel:[0,0,1] op_sel_hi:[1,0,1]
    v_pk_fma_f32 v[16:17], v[16:17], s[38:39], v[6:7] op_sel:[0,0,1] op_sel_hi:[1,0,1]
    v_pk_fma_f32 v[18:19], v[18:19], s[38:39], v[6:7] op_sel:[0,0,1] op_sel_hi:[1,0,1]
    v_cvt_pk_bf16_f32 v88, v12, v13
    v_cvt_pk_bf16_f32 v89, v14, v15
    v_cvt_pk_bf16_f32 v90, v16, v17
    v_cvt_pk_bf16_f32 v91, v18, v19
    buffer_store_dwordx4 v[88:91], v0, s[8:11], s35 offen offset:1024 sc1
    s_waitcnt vmcnt(15)
    s_mov_b32 s57, 20000
    s_mov_b64 exec, 0xff
L_chk_9:
    v_cmp_eq_u32 vcc, s34, v9
    v_cmp_eq_u32 s[58:59], s65, v11
    s_nop 1
    s_and_b64 vcc, vcc, s[58:59]
    s_cmp_eq_u64 vcc, exec
    s_cbranch_scc1 L_ok_10
    s_sub_u32 s57, s57, 1
    s_cmp_eq_u32 s57, 0
    s_cbranch_scc1 L_ok_10
    s_sleep 8
    v_subrev_u32 v16, s43, v2
    buffer_load_dwordx4 v[8:11], v16, s[12:15], s55 offen sc1
    s_waitcnt vmcnt(0)
    s_branch L_chk_9
L_ok_10:
    s_nop 1
    v_add_f32_dpp v8, v8, v8 row_shr:1 row_mask:0xf bank_mask:0xf
    v_add_f32_dpp v10, v10, v10 row_shr:1 row_mask:0xf bank_mask:0xf
    s_nop 1
    v_add_f32_dpp v8, v8, v8 row_shr:2 row_mask:0xf bank_mask:0xf
    v_add_f32_dpp v10, v10, v10 row_shr:2 row_mask:0xf bank_mask:0xf
    s_nop 1
    v_add_f32_dpp v8, v8, v8 row_shr:4 row_mask:0xf bank_mask:0xf
    v_add_f32_dpp v10, v10, v10 row_shr:4 row_mask:0xf bank_mask:0xf
    s_mov_b64 exec, -1
    s_nop 1
    v_readlane_b32 s58, v8, 7
    v_readlane_b32 s59, v10, 7
    s_mov_b32 s57, 0x35638e39
    v_mov_b32 v12, s58
    v_mov_b32 v13, s59
    v_mul_f32 v12, s57, v12
    v_mul_f32 v13, s57, v13
    v_fma_f32 v13, -v12, v12, v13
    v_max_f32 v13, 0, v13
    v_add_f32 v13, 0x3727c5ac, v13
    v_rsq_f32 v13, v13
    v_add_f32 v12, s32, v12
    v_lshlrev_b32 v14, 16, v3
    v_and_b32 v15, s42, v3
    v_mul_f32 v4, v14, v13
    v_fma_f32 v5, -v12, v4, v15
    s_mov_b32 s35, s29
    v_readlane_b32 s40, v5, 0
    v_readlane_b32 s36, v4, 0
    s_nop 0
    v_mov_b32 v6, s40
    v_lshlrev_b32 v12, 16, v92
    v_and_b32 v13, s42, v92
    v_lshlrev_b32 v14, 16, v93
    v_and_b32 v15, s42, v93
    v_lshlrev_b32 v16, 16, v94
    v_and_b32 v17, s42, v94
    v_lshlrev_b32 v18, 16, v95
    v_and_b32 v19, s42, v95
    v_pk_fma_f32 v[12:13], v[12:13], s[36:37], v[6:7] op_sel_hi:[1,0,0]
    v_pk_fma_f32 v[14:15], v[14:15], s[36:37], v[6:7] op_sel_hi:[1,0,0]
    v_pk_fma_f32 v[16:17], v[16:17], s[36:37], v[6:7] op_sel_hi:[1,0,0]
    v_pk_fma_f32 v[18:19], v[18:19], s[36:37], v[6:7] op_sel_hi:[1,0,0]
    v_cvt_pk_bf16_f32 v92, v12, v13
    v_cvt_pk_bf16_f32 v93, v14, v15
    v_cvt_pk_bf16_f32 v94, v16, v17
    v_cvt_pk_bf16_f32 v95, v18, v19
    buffer_store_dwordx4 v[92:95], v0, s[8:11], s35 offen sc1
    v_lshlrev_b32 v12, 16, v96
    v_and_b32 v13, s42, v96
    v_lshlrev_b32 v14, 16, v97
    v_and_b32 v15, s42, v97
    v_lshlrev_b32 v16, 16, v98
    v_and_b32 v17, s42, v98
    v_lshlrev_b32 v18, 16, v99
    v_and_b32 v19, s42, v99
    v_pk_fma_f32 v[12:13], v[12:13], s[36:37], v[6:7] op_sel_hi:[1,0,0]
    v_pk_fma_f32 v[14:15], v[14:15], s[36:37], v[6:7] op_sel_hi:[1,0,0]
    v_pk_fma_f32 v[16:17], v[16:17], s[36:37], v[6:7] op_sel_hi:[1,0,0]
    v_pk_fma_f32 v[18:19], v[18:19], s[36:37], v[6:7] op_sel_hi:[1,0,0]
    v_cvt_pk_bf16_f32 v96, v12, v13
    v_cvt_pk_bf16_f32 v97, v14, v15
    v_cvt_pk_bf16_f32 v98, v16, v17
    v_cvt_pk_bf16_f32 v99, v18, v19
    buffer_store_dwordx4 v[96:99], v0, s[8:11], s35 offen offset:1024 sc1
    s_add_u32 s35, s35, 131072
    v_readlane_b32 s40, v5, 1
    v_readlane_b32 s38, v4, 1
    s_nop 0
    v_mov_b32 v7, s40
    v_lshlrev_b32 v12, 16, v100
    v_and_b32 v13, s42, v100
    v_lshlrev_b32 v14, 16, v101
    v_and_b32 v15, s42, v101
    v_lshlrev_b32 v16, 16, v102
    v_and_b32 v17, s42, v102
    v_lshlrev_b32 v18, 16, v103
    v_and_b32 v19, s42, v103
    v_pk_fma_f32 v[12:13], v[12:13], s[38:39], v[6:7] op_sel:[0,0,1] op_sel_hi:[1,0,1]
    v_pk_fma_f32 v[14:15], v[14:15], s[38:39], v[6:7] op_sel:[0,0,1] op_sel_hi:[1,0,1]
    v_pk_fma_f32 v[16:17], v[16:17], s[38:39], v[6:7] op_sel:[0,0,1] op_sel_hi:[1,0,1]
    v_pk_fma_f32 v[18:19], v[18:19], s[38:39], v[6:7] op_sel:[0,0,1] op_sel_hi:[1,0,1]
    v_cvt_pk_bf16_f32 v100, v12, v13
    v_cvt_pk_bf16_f32 v101, v14, v15
    v_cvt_pk_bf16_f32 v102, v16, v17
    v_cvt_pk_bf16_f32 v103, v18, v19
    buffer_store_dwordx4 v[100:103], v0, s[8:11], s35 offen sc1
    v_lshlrev_b32 v12, 16, v104
    v_and_b32 v13, s42, v104
    v_lshlrev_b32 v14, 16, v105
    v_and_b32 v15, s42, v105
    v_lshlrev_b32 v16, 16, v106
    v_and_b32 v17, s42, v106
    v_lshlrev_b32 v18, 16, v107
    v_and_b32 v19, s42, v107
    v_pk_fma_f32 v[12:13], v[12:13], s[38:39], v[6:7] op_sel:[0,0,1] op_sel_hi:[1,0,1]
    v_pk_fma_f32 v[14:15], v[14:15], s[38:39], v[6:7] op_sel:[0,0,1] op_sel_hi:[1,0,1]
    v_pk_fma_f32 v[16:17], v[16:17], s[38:39], v[6:7] op_sel:[0,0,1] op_sel_hi:[1,0,1]
    v_pk_fma_f32 v[18:19], v[18:19], s[38:39], v[6:7] op_sel:[0,0,1] op_sel_hi:[1,0,1]
    v_cvt_pk_bf16_f32 v104, v12, v13
    v_cvt_pk_bf16_f32 v105, v14, v15
    v_cvt_pk_bf16_f32 v106, v16, v17
    v_cvt_pk_bf16_f32 v107, v18, v19
    buffer_store_dwordx4 v[104:107], v0, s[8:11], s35 offen offset:1024 sc1
    s_add_u32 s35, s35, 131072
    v_readlane_b32 s40, v5, 2
    v_readlane_b32 s36, v4, 2
    s_nop 0
    v_mov_b32 v6, s40
    v_lshlrev_b32 v12, 16, v108
    v_and_b32 v13, s42, v108
    v_lshlrev_b32 v14, 16, v109
    v_and_b32 v15, s42, v109
    v_lshlrev_b32 v16, 16, v110
    v_and_b32 v17, s42, v110
    v_lshlrev_b32 v18, 16, v111
    v_and_b32 v19, s42, v111
    v_pk_fma_f32 v[12:13], v[12:13], s[36:37], v[6:7] op_sel_hi:[1,0,0]
    v_pk_fma_f32 v[14:15], v[14:15], s[36:37], v[6:7] op_sel_hi:[1,0,0]
    v_pk_fma_f32 v[16:17], v[16:17], s[36:37], v[6:7] op_sel_hi:[1,0,0]
    v_pk_fma_f32 v[18:19], v[18:19], s[36:37], v[6:7] op_sel_hi:[1,0,0]
    v_cvt_pk_bf16_f32 v108, v12, v13
    v_cvt_pk_bf16_f32 v109, v14, v15
    v_cvt_pk_bf16_f32 v110, v16, v17
    v_cvt_pk_bf16_f32 v111, v18, v19
    buffer_store_dwordx4 v[108:111], v0, s[8:11], s35 offen sc1
    v_lshlrev_b32 v12, 16, v112
    v_and_b32 v13, s42, v112
    v_lshlrev_b32 v14, 16, v113
    v_and_b32 v15, s42, v113
    v_lshlrev_b32 v16, 16, v114
    v_and_b32 v17, s42, v114
    v_lshlrev_b32 v18, 16, v115
    v_and_b32 v19, s42, v115
    v_pk_fma_f32 v[12:13], v[12:13], s[36:37], v[6:7] op_sel_hi:[1,0,0]
    v_pk_fma_f32 v[14:15], v[14:15], s[36:37], v[6:7] op_sel_hi:[1,0,0]
    v_pk_fma_f32 v[16:17], v[16:17], s[36:37], v[6:7] op_sel_hi:[1,0,0]
    v_pk_fma_f32 v[18:19], v[18:19], s[36:37], v[6:7] op_sel_hi:[1,0,0]
    v_cvt_pk_bf16_f32 v112, v12, v13
    v_cvt_pk_bf16_f32 v113, v14, v15
    v_cvt_pk_bf16_f32 v114, v16, v17
    v_cvt_pk_bf16_f32 v115, v18, v19
    buffer_store_dwordx4 v[112:115], v0, s[8:11], s35 offen offset:1024 sc1
    s_add_u32 s35, s35, 131072
    v_readlane_b32 s40, v5, 3
    v_readlane_b32 s38, v4, 3
    s_nop 0
    v_mov_b32 v7, s40
    v_lshlrev_b32 v12, 16, v116
    v_and_b32 v13, s42, v116
    v_lshlrev_b32 v14, 16, v117
    v_and_b32 v15, s42, v117
    v_lshlrev_b32 v16, 16, v118
    v_and_b32 v17, s42, v118
    v_lshlrev_b32 v18, 16, v119
    v_and_b32 v19, s42, v119
    v_pk_fma_f32 v[12:13], v[12:13], s[38:39], v[6:7] op_sel:[0,0,1] op_sel_hi:[1,0,1]
    v_pk_fma_f32 v[14:15], v[14:15], s[38:39], v[6:7] op_sel:[0,0,1] op_sel_hi:[1,0,1]
    v_pk_fma_f32 v[16:17], v[16:17], s[38:39], v[6:7] op_sel:[0,0,1] op_sel_hi:[1,0,1]
    v_pk_fma_f32 v[18:19], v[18:19], s[38:39], v[6:7] op_sel:[0,0,1] op_sel_hi:[1,0,1]
    v_cvt_pk_bf16_f32 v116, v12, v13
    v_cvt_pk_bf16_f32 v117, v14, v15
    v_cvt_pk_bf16_f32 v118, v16, v17
    v_cvt_pk_bf16_f32 v119, v18, v19
    buffer_store_dwordx4 v[116:119], v0, s[8:11], s35 offen sc1
    v_lshlrev_b32 v12, 16, v120
    v_and_b32 v13, s42, v120
    v_lshlrev_b32 v14, 16, v121
    v_and_b32 v15, s42, v121
    v_lshlrev_b32 v16, 16, v122
    v_and_b32 v17, s42, v122
    v_lshlrev_b32 v18, 16, v123
    v_and_b32 v19, s42, v123
    v_pk_fma_f32 v[12:13], v[12:13], s[38:39], v[6:7] op_sel:[0,0,1] op_sel_hi:[1,0,1]
    v_pk_fma_f32 v[14:15], v[14:15], s[38:39], v[6:7] op_sel:[0,0,1] op_sel_hi:[1,0,1]
    v_pk_fma_f32 v[16:17], v[16:17], s[38:39], v[6:7] op_sel:[0,0,1] op_sel_hi:[1,0,1]
    v_pk_fma_f32 v[18:19], v[18:19], s[38:39], v[6:7] op_sel:[0,0,1] op_sel_hi:[1,0,1]
    v_cvt_pk_bf16_f32 v120, v12, v13
    v_cvt_pk_bf16_f32 v121, v14, v15
    v_cvt_pk_bf16_f32 v122, v16, v17
    v_cvt_pk_bf16_f32 v123, v18, v19
    buffer_store_dwordx4 v[120:123], v0, s[8:11], s35 offen offset:1024 sc1
    s_add_u32 s35, s35, 131072
    v_readlane_b32 s40, v5, 4
    v_readlane_b32 s36, v4, 4
    s_nop 0
    v_mov_b32 v6, s40
    v_lshlrev_b32 v12, 16, v124
    v_and_b32 v13, s42, v124
    v_lshlrev_b32 v14, 16, v125
    v_and_b32 v15, s42, v125
    v_lshlrev_b32 v16, 16, v126
    v_and_b32 v17, s42, v126
    v_lshlrev_b32 v18, 16, v127
    v_and_b32 v19, s42, v127
    v_pk_fma_f32 v[12:13], v[12:13], s[36:37], v[6:7] op_sel_hi:[1,0,0]
    v_pk_fma_f32 v[14:15], v[14:15], s[36:37], v[6:7] op_sel_hi:[1,0,0]
    v_pk_fma_f32 v[16:17], v[16:17], s[36:37], v[6:7] op_sel_hi:[1,0,0]
    v_pk_fma_f32 v[18:19], v[18:19], s[36:37], v[6:7] op_sel_hi:[1,0,0]
    v_cvt_pk_bf16_f32 v124, v12, v13
    v_cvt_pk_bf16_f32 v125, v14, v15
    v_cvt_pk_bf16_f32 v126, v16, v17
    v_cvt_pk_bf16_f32 v127, v18, v19
    buffer_store_dwordx4 v[124:127], v0, s[8:11], s35 offen sc1
    v_lshlrev_b32 v12, 16, v128
    v_and_b32 v13, s42, v128
    v_lshlrev_b32 v14, 16, v129
    v_and_b32 v15, s42, v129
    v_lshlrev_b32 v16, 16, v130
    v_and_b32 v17, s42, v130
    v_lshlrev_b32 v18, 16, v131
    v_and_b32 v19, s42, v131
    v_pk_fma_f32 v[12:13], v[12:13], s[36:37], v[6:7] op_sel_hi:[1,0,0]
    v_pk_fma_f32 v[14:15], v[14:15], s[36:37], v[6:7] op_sel_hi:[1,0,0]
    v_pk_fma_f32 v[16:17], v[16:17], s[36:37], v[6:7] op_sel_hi:[1,0,0]
    v_pk_fma_f32 v[18:19], v[18:19], s[36:37], v[6:7] op_sel_hi:[1,0,0]
    v_cvt_pk_bf16_f32 v128, v12, v13
    v_cvt_pk_bf16_f32 v129, v14, v15
    v_cvt_pk_bf16_f32 v130, v16, v17
    v_cvt_pk_bf16_f32 v131, v18, v19
    buffer_store_dwordx4 v[128:131], v0, s[8:11], s35 offen offset:1024 sc1
    s_add_u32 s35, s35, 131072
    v_readlane_b32 s40, v5, 5
    v_readlane_b32 s38, v4, 5
    s_nop 0
    v_mov_b32 v7, s40
    v_lshlrev_b32 v12, 16, v132
    v_and_b32 v13, s42, v132
    v_lshlrev_b32 v14, 16, v133
    v_and_b32 v15, s42, v133
    v_lshlrev_b32 v16, 16, v134
    v_and_b32 v17, s42, v134
    v_lshlrev_b32 v18, 16, v135
    v_and_b32 v19, s42, v135
    v_pk_fma_f32 v[12:13], v[12:13], s[38:39], v[6:7] op_sel:[0,0,1] op_sel_hi:[1,0,1]
    v_pk_fma_f32 v[14:15], v[14:15], s[38:39], v[6:7] op_sel:[0,0,1] op_sel_hi:[1,0,1]
    v_pk_fma_f32 v[16:17], v[16:17], s[38:39], v[6:7] op_sel:[0,0,1] op_sel_hi:[1,0,1]
    v_pk_fma_f32 v[18:19], v[18:19], s[38:39], v[6:7] op_sel:[0,0,1] op_sel_hi:[1,0,1]
    v_cvt_pk_bf16_f32 v132, v12, v13
    v_cvt_pk_bf16_f32 v133, v14, v15
    v_cvt_pk_bf16_f32 v134, v16, v17
    v_cvt_pk_bf16_f32 v135, v18, v19
    buffer_store_dwordx4 v[132:135], v0, s[8:11], s35 offen sc1
    v_lshlrev_b32 v12, 16, v136
    v_and_b32 v13, s42, v136
    v_lshlrev_b32 v14, 16, v137
    v_and_b32 v15, s42, v137
    v_lshlrev_b32 v16, 16, v138
    v_and_b32 v17, s42, v138
    v_lshlrev_b32 v18, 16, v139
    v_and_b32 v19, s42, v139
    v_pk_fma_f32 v[12:13], v[12:13], s[38:39], v[6:7] op_sel:[0,0,1] op_sel_hi:[1,0,1]
    v_pk_fma_f32 v[14:15], v[14:15], s[38:39], v[6:7] op_sel:[0,0,1] op_sel_hi:[1,0,1]
    v_pk_fma_f32 v[16:17], v[16:17], s[38:39], v[6:7] op_sel:[0,0,1] op_sel_hi:[1,0,1]
    v_pk_fma_f32 v[18:19], v[18:19], s[38:39], v[6:7] op_sel:[0,0,1] op_sel_hi:[1,0,1]
    v_cvt_pk_bf16_f32 v136, v12, v13
    v_cvt_pk_bf16_f32 v137, v14, v15
    v_cvt_pk_bf16_f32 v138, v16, v17
    v_cvt_pk_bf16_f32 v139, v18, v19
    buffer_store_dwordx4 v[136:139], v0, s[8:11], s35 offen offset:1024 sc1
    s_add_u32 s35, s35, 131072
    v_readlane_b32 s40, v5, 6
    v_readlane_b32 s36, v4, 6
    s_nop 0
    v_mov_b32 v6, s40
    v_lshlrev_b32 v12, 16, v140
    v_and_b32 v13, s42, v140
    v_lshlrev_b32 v14, 16, v141
    v_and_b32 v15, s42, v141
    v_lshlrev_b32 v16, 16, v142
    v_and_b32 v17, s42, v142
    v_lshlrev_b32 v18, 16, v143
    v_and_b32 v19, s42, v143
    v_pk_fma_f32 v[12:13], v[12:13], s[36:37], v[6:7] op_sel_hi:[1,0,0]
    v_pk_fma_f32 v[14:15], v[14:15], s[36:37], v[6:7] op_sel_hi:[1,0,0]
    v_pk_fma_f32 v[16:17], v[16:17], s[36:37], v[6:7] op_sel_hi:[1,0,0]
    v_pk_fma_f32 v[18:19], v[18:19], s[36:37], v[6:7] op_sel_hi:[1,0,0]
    v_cvt_pk_bf16_f32 v140, v12, v13
    v_cvt_pk_bf16_f32 v141, v14, v15
    v_cvt_pk_bf16_f32 v142, v16, v17
    v_cvt_pk_bf16_f32 v143, v18, v19
    buffer_store_dwordx4 v[140:143], v0, s[8:11], s35 offen sc1
    v_lshlrev_b32 v12, 16, v144
    v_and_b32 v13, s42, v144
    v_lshlrev_b32 v14, 16, v145
    v_and_b32 v15, s42, v145
    v_lshlrev_b32 v16, 16, v146
    v_and_b32 v17, s42, v146
    v_lshlrev_b32 v18, 16, v147
    v_and_b32 v19, s42, v147
    v_pk_fma_f32 v[12:13], v[12:13], s[36:37], v[6:7] op_sel_hi:[1,0,0]
    v_pk_fma_f32 v[14:15], v[14:15], s[36:37], v[6:7] op_sel_hi:[1,0,0]
    v_pk_fma_f32 v[16:17], v[16:17], s[36:37], v[6:7] op_sel_hi:[1,0,0]
    v_pk_fma_f32 v[18:19], v[18:19], s[36:37], v[6:7] op_sel_hi:[1,0,0]
    v_cvt_pk_bf16_f32 v144, v12, v13
    v_cvt_pk_bf16_f32 v145, v14, v15
    v_cvt_pk_bf16_f32 v146, v16, v17
    v_cvt_pk_bf16_f32 v147, v18, v19
    buffer_store_dwordx4 v[144:147], v0, s[8:11], s35 offen offset:1024 sc1
    s_add_u32 s35, s35, 131072
    v_readlane_b32 s40, v5, 7
    v_readlane_b32 s38, v4, 7
    s_nop 0
    v_mov_b32 v7, s40
    v_lshlrev_b32 v12, 16, v148
    v_and_b32 v13, s42, v148
    v_lshlrev_b32 v14, 16, v149
    v_and_b32 v15, s42, v149
    v_lshlrev_b32 v16, 16, v150
    v_and_b32 v17, s42, v150
    v_lshlrev_b32 v18, 16, v151
    v_and_b32 v19, s42, v151
    v_pk_fma_f32 v[12:13], v[12:13], s[38:39], v[6:7] op_sel:[0,0,1] op_sel_hi:[1,0,1]
    v_pk_fma_f32 v[14:15], v[14:15], s[38:39], v[6:7] op_sel:[0,0,1] op_sel_hi:[1,0,1]
    v_pk_fma_f32 v[16:17], v[16:17], s[38:39], v[6:7] op_sel:[0,0,1] op_sel_hi:[1,0,1]
    v_pk_fma_f32 v[18:19], v[18:19], s[38:39], v[6:7] op_sel:[0,0,1] op_sel_hi:[1,0,1]
    v_cvt_pk_bf16_f32 v148, v12, v13
    v_cvt_pk_bf16_f32 v149, v14, v15
    v_cvt_pk_bf16_f32 v150, v16, v17
    v_cvt_pk_bf16_f32 v151, v18, v19
    buffer_store_dwordx4 v[148:151], v0, s[8:11], s35 offen sc1
    v_lshlrev_b32 v12, 16, v152
    v_and_b32 v13, s42, v152
    v_lshlrev_b32 v14, 16, v153
    v_and_b32 v15, s42, v153
    v_lshlrev_b32 v16, 16, v154
    v_and_b32 v17, s42, v154
    v_lshlrev_b32 v18, 16, v155
    v_and_b32 v19, s42, v155
    v_pk_fma_f32 v[12:13], v[12:13], s[38:39], v[6:7] op_sel:[0,0,1] op_sel_hi:[1,0,1]
    v_pk_fma_f32 v[14:15], v[14:15], s[38:39], v[6:7] op_sel:[0,0,1] op_sel_hi:[1,0,1]
    v_pk_fma_f32 v[16:17], v[16:17], s[38:39], v[6:7] op_sel:[0,0,1] op_sel_hi:[1,0,1]
    v_pk_fma_f32 v[18:19], v[18:19], s[38:39], v[6:7] op_sel:[0,0,1] op_sel_hi:[1,0,1]
    v_cvt_pk_bf16_f32 v152, v12, v13
    v_cvt_pk_bf16_f32 v153, v14, v15
    v_cvt_pk_bf16_f32 v154, v16, v17
    v_cvt_pk_bf16_f32 v155, v18, v19
    buffer_store_dwordx4 v[152:155], v0, s[8:11], s35 offen offset:1024 sc1
    s_add_u32 s35, s35, 131072
    v_readlane_b32 s40, v5, 8
    v_readlane_b32 s36, v4, 8
    s_nop 0
    v_mov_b32 v6, s40
    v_lshlrev_b32 v12, 16, v156
    v_and_b32 v13, s42, v156
    v_lshlrev_b32 v14, 16, v157
    v_and_b32 v15, s42, v157
    v_lshlrev_b32 v16, 16, v158
    v_and_b32 v17, s42, v158
    v_lshlrev_b32 v18, 16, v159
    v_and_b32 v19, s42, v159
    v_pk_fma_f32 v[12:13], v[12:13], s[36:37], v[6:7] op_sel_hi:[1,0,0]
    v_pk_fma_f32 v[14:15], v[14:15], s[36:37], v[6:7] op_sel_hi:[1,0,0]
    v_pk_fma_f32 v[16:17], v[16:17], s[36:37], v[6:7] op_sel_hi:[1,0,0]
    v_pk_fma_f32 v[18:19], v[18:19], s[36:37], v[6:7] op_sel_hi:[1,0,0]
    v_cvt_pk_bf16_f32 v156, v12, v13
    v_cvt_pk_bf16_f32 v157, v14, v15
    v_cvt_pk_bf16_f32 v158, v16, v17
    v_cvt_pk_bf16_f32 v159, v18, v19
    buffer_store_dwordx4 v[156:159], v0, s[8:11], s35 offen sc1
    v_lshlrev_b32 v12, 16, v160
    v_and_b32 v13, s42, v160
    v_lshlrev_b32 v14, 16, v161
    v_and_b32 v15, s42, v161
    v_lshlrev_b32 v16, 16, v162
    v_and_b32 v17, s42, v162
    v_lshlrev_b32 v18, 16, v163
    v_and_b32 v19, s42, v163
    v_pk_fma_f32 v[12:13], v[12:13], s[36:37], v[6:7] op_sel_hi:[1,0,0]
    v_pk_fma_f32 v[14:15], v[14:15], s[36:37], v[6:7] op_sel_hi:[1,0,0]
    v_pk_fma_f32 v[16:17], v[16:17], s[36:37], v[6:7] op_sel_hi:[1,0,0]
    v_pk_fma_f32 v[18:19], v[18:19], s[36:37], v[6:7] op_sel_hi:[1,0,0]
    v_cvt_pk_bf16_f32 v160, v12, v13
    v_cvt_pk_bf16_f32 v161, v14, v15
    v_cvt_pk_bf16_f32 v162, v16, v17
    v_cvt_pk_bf16_f32 v163, v18, v19
    buffer_store_dwordx4 v[160:163], v0, s[8:11], s35 offen offset:1024 sc1
    s_add_u32 s35, s35, 131072
    v_readlane_b32 s40, v5, 9
    v_readlane_b32 s38, v4, 9
    s_nop 0
    v_mov_b32 v7, s40
    v_lshlrev_b32 v12, 16, v164
    v_and_b32 v13, s42, v164
    v_lshlrev_b32 v14, 16, v165
    v_and_b32 v15, s42, v165
    v_lshlrev_b32 v16, 16, v166
    v_and_b32 v17, s42, v166
    v_lshlrev_b32 v18, 16, v167
    v_and_b32 v19, s42, v167
    v_pk_fma_f32 v[12:13], v[12:13], s[38:39], v[6:7] op_sel:[0,0,1] op_sel_hi:[1,0,1]
    v_pk_fma_f32 v[14:15], v[14:15], s[38:39], v[6:7] op_sel:[0,0,1] op_sel_hi:[1,0,1]
    v_pk_fma_f32 v[16:17], v[16:17], s[38:39], v[6:7] op_sel:[0,0,1] op_sel_hi:[1,0,1]
    v_pk_fma_f32 v[18:19], v[18:19], s[38:39], v[6:7] op_sel:[0,0,1] op_sel_hi:[1,0,1]
    v_cvt_pk_bf16_f32 v164, v12, v13
    v_cvt_pk_bf16_f32 v165, v14, v15
    v_cvt_pk_bf16_f32 v166, v16, v17
    v_cvt_pk_bf16_f32 v167, v18, v19
    buffer_store_dwordx4 v[164:167], v0, s[8:11], s35 offen sc1
    v_lshlrev_b32 v12, 16, v168
    v_and_b32 v13, s42, v168
    v_lshlrev_b32 v14, 16, v169
    v_and_b32 v15, s42, v169
    v_lshlrev_b32 v16, 16, v170
    v_and_b32 v17, s42, v170
    v_lshlrev_b32 v18, 16, v171
    v_and_b32 v19, s42, v171
    v_pk_fma_f32 v[12:13], v[12:13], s[38:39], v[6:7] op_sel:[0,0,1] op_sel_hi:[1,0,1]
    v_pk_fma_f32 v[14:15], v[14:15], s[38:39], v[6:7] op_sel:[0,0,1] op_sel_hi:[1,0,1]
    v_pk_fma_f32 v[16:17], v[16:17], s[38:39], v[6:7] op_sel:[0,0,1] op_sel_hi:[1,0,1]
    v_pk_fma_f32 v[18:19], v[18:19], s[38:39], v[6:7] op_sel:[0,0,1] op_sel_hi:[1,0,1]
    v_cvt_pk_bf16_f32 v168, v12, v13
    v_cvt_pk_bf16_f32 v169, v14, v15
    v_cvt_pk_bf16_f32 v170, v16, v17
    v_cvt_pk_bf16_f32 v171, v18, v19
    buffer_store_dwordx4 v[168:171], v0, s[8:11], s35 offen offset:1024 sc1
    s_add_u32 s35, s35, 131072
    v_readlane_b32 s40, v5, 10
    v_readlane_b32 s36, v4, 10
    s_nop 0
    v_mov_b32 v6, s40
    v_lshlrev_b32 v12, 16, v172
    v_and_b32 v13, s42, v172
    v_lshlrev_b32 v14, 16, v173
    v_and_b32 v15, s42, v173
    v_lshlrev_b32 v16, 16, v174
    v_and_b32 v17, s42, v174
    v_lshlrev_b32 v18, 16, v175
    v_and_b32 v19, s42, v175
    v_pk_fma_f32 v[12:13], v[12:13], s[36:37], v[6:7] op_sel_hi:[1,0,0]
    v_pk_fma_f32 v[14:15], v[14:15], s[36:37], v[6:7] op_sel_hi:[1,0,0]
    v_pk_fma_f32 v[16:17], v[16:17], s[36:37], v[6:7] op_sel_hi:[1,0,0]
    v_pk_fma_f32 v[18:19], v[18:19], s[36:37], v[6:7] op_sel_hi:[1,0,0]
    v_cvt_pk_bf16_f32 v172, v12, v13
    v_cvt_pk_bf16_f32 v173, v14, v15
    v_cvt_pk_bf16_f32 v174, v16, v17
    v_cvt_pk_bf16_f32 v175, v18, v19
    buffer_store_dwordx4 v[172:175], v0, s[8:11], s35 offen sc1
    v_lshlrev_b32 v12, 16, v176
    v_and_b32 v13, s42, v176
    v_lshlrev_b32 v14, 16, v177
    v_and_b32 v15, s42, v177
    v_lshlrev_b32 v16, 16, v178
    v_and_b32 v17, s42, v178
    v_lshlrev_b32 v18, 16, v179
    v_and_b32 v19, s42, v179
    v_pk_fma_f32 v[12:13], v[12:13], s[36:37], v[6:7] op_sel_hi:[1,0,0]
    v_pk_fma_f32 v[14:15], v[14:15], s[36:37], v[6:7] op_sel_hi:[1,0,0]
    v_pk_fma_f32 v[16:17], v[16:17], s[36:37], v[6:7] op_sel_hi:[1,0,0]
    v_pk_fma_f32 v[18:19], v[18:19], s[36:37], v[6:7] op_sel_hi:[1,0,0]
    v_cvt_pk_bf16_f32 v176, v12, v13
    v_cvt_pk_bf16_f32 v177, v14, v15
    v_cvt_pk_bf16_f32 v178, v16, v17
    v_cvt_pk_bf16_f32 v179, v18, v19
    buffer_store_dwordx4 v[176:179], v0, s[8:11], s35 offen offset:1024 sc1
    s_add_u32 s35, s35, 131072
    v_readlane_b32 s40, v5, 11
    v_readlane_b32 s38, v4, 11
    s_nop 0
    v_mov_b32 v7, s40
    v_lshlrev_b32 v12, 16, v180
    v_and_b32 v13, s42, v180
    v_lshlrev_b32 v14, 16, v181
    v_and_b32 v15, s42, v181
    v_lshlrev_b32 v16, 16, v182
    v_and_b32 v17, s42, v182
    v_lshlrev_b32 v18, 16, v183
    v_and_b32 v19, s42, v183
    v_pk_fma_f32 v[12:13], v[12:13], s[38:39], v[6:7] op_sel:[0,0,1] op_sel_hi:[1,0,1]
    v_pk_fma_f32 v[14:15], v[14:15], s[38:39], v[6:7] op_sel:[0,0,1] op_sel_hi:[1,0,1]
    v_pk_fma_f32 v[16:17], v[16:17], s[38:39], v[6:7] op_sel:[0,0,1] op_sel_hi:[1,0,1]
    v_pk_fma_f32 v[18:19], v[18:19], s[38:39], v[6:7] op_sel:[0,0,1] op_sel_hi:[1,0,1]
    v_cvt_pk_bf16_f32 v180, v12, v13
    v_cvt_pk_bf16_f32 v181, v14, v15
    v_cvt_pk_bf16_f32 v182, v16, v17
    v_cvt_pk_bf16_f32 v183, v18, v19
    buffer_store_dwordx4 v[180:183], v0, s[8:11], s35 offen sc1
    v_lshlrev_b32 v12, 16, v184
    v_and_b32 v13, s42, v184
    v_lshlrev_b32 v14, 16, v185
    v_and_b32 v15, s42, v185
    v_lshlrev_b32 v16, 16, v186
    v_and_b32 v17, s42, v186
    v_lshlrev_b32 v18, 16, v187
    v_and_b32 v19, s42, v187
    v_pk_fma_f32 v[12:13], v[12:13], s[38:39], v[6:7] op_sel:[0,0,1] op_sel_hi:[1,0,1]
    v_pk_fma_f32 v[14:15], v[14:15], s[38:39], v[6:7] op_sel:[0,0,1] op_sel_hi:[1,0,1]
    v_pk_fma_f32 v[16:17], v[16:17], s[38:39], v[6:7] op_sel:[0,0,1] op_sel_hi:[1,0,1]
    v_pk_fma_f32 v[18:19], v[18:19], s[38:39], v[6:7] op_sel:[0,0,1] op_sel_hi:[1,0,1]
    v_cvt_pk_bf16_f32 v184, v12, v13
    v_cvt_pk_bf16_f32 v185, v14, v15
    v_cvt_pk_bf16_f32 v186, v16, v17
    v_cvt_pk_bf16_f32 v187, v18, v19
    buffer_store_dwordx4 v[184:187], v0, s[8:11], s35 offen offset:1024 sc1
    s_add_u32 s35, s35, 131072
    v_readlane_b32 s40, v5, 12
    v_readlane_b32 s36, v4, 12
    s_nop 0
    v_mov_b32 v6, s40
    v_lshlrev_b32 v12, 16, v188
    v_and_b32 v13, s42, v188
    v_lshlrev_b32 v14, 16, v189
    v_and_b32 v15, s42, v189
    v_lshlrev_b32 v16, 16, v190
    v_and_b32 v17, s42, v190
    v_lshlrev_b32 v18, 16, v191
    v_and_b32 v19, s42, v191
    v_pk_fma_f32 v[12:13], v[12:13], s[36:37], v[6:7] op_sel_hi:[1,0,0]
    v_pk_fma_f32 v[14:15], v[14:15], s[36:37], v[6:7] op_sel_hi:[1,0,0]
    v_pk_fma_f32 v[16:17], v[16:17], s[36:37], v[6:7] op_sel_hi:[1,0,0]
    v_pk_fma_f32 v[18:19], v[18:19], s[36:37], v[6:7] op_sel_hi:[1,0,0]
    v_cvt_pk_bf16_f32 v188, v12, v13
    v_cvt_pk_bf16_f32 v189, v14, v15
    v_cvt_pk_bf16_f32 v190, v16, v17
    v_cvt_pk_bf16_f32 v191, v18, v19
    buffer_store_dwordx4 v[188:191], v0, s[8:11], s35 offen sc1
    v_lshlrev_b32 v12, 16, v192
    v_and_b32 v13, s42, v192
    v_lshlrev_b32 v14, 16, v193
    v_and_b32 v15, s42, v193
    v_lshlrev_b32 v16, 16, v194
    v_and_b32 v17, s42, v194
    v_lshlrev_b32 v18, 16, v195
    v_and_b32 v19, s42, v195
    v_pk_fma_f32 v[12:13], v[12:13], s[36:37], v[6:7] op_sel_hi:[1,0,0]
    v_pk_fma_f32 v[14:15], v[14:15], s[36:37], v[6:7] op_sel_hi:[1,0,0]
    v_pk_fma_f32 v[16:17], v[16:17], s[36:37], v[6:7] op_sel_hi:[1,0,0]
    v_pk_fma_f32 v[18:19], v[18:19], s[36:37], v[6:7] op_sel_hi:[1,0,0]
    v_cvt_pk_bf16_f32 v192, v12, v13
    v_cvt_pk_bf16_f32 v193, v14, v15
    v_cvt_pk_bf16_f32 v194, v16, v17
    v_cvt_pk_bf16_f32 v195, v18, v19
    buffer_store_dwordx4 v[192:195], v0, s[8:11], s35 offen offset:1024 sc1
    s_add_u32 s35, s35, 131072
    v_readlane_b32 s40, v5, 13
    v_readlane_b32 s38, v4, 13
    s_nop 0
    v_mov_b32 v7, s40
    v_lshlrev_b32 v12, 16, v196
    v_and_b32 v13, s42, v196
    v_lshlrev_b32 v14, 16, v197
    v_and_b32 v15, s42, v197
    v_lshlrev_b32 v16, 16, v198
    v_and_b32 v17, s42, v198
    v_lshlrev_b32 v18, 16, v199
    v_and_b32 v19, s42, v199
    v_pk_fma_f32 v[12:13], v[12:13], s[38:39], v[6:7] op_sel:[0,0,1] op_sel_hi:[1,0,1]
    v_pk_fma_f32 v[14:15], v[14:15], s[38:39], v[6:7] op_sel:[0,0,1] op_sel_hi:[1,0,1]
    v_pk_fma_f32 v[16:17], v[16:17], s[38:39], v[6:7] op_sel:[0,0,1] op_sel_hi:[1,0,1]
    v_pk_fma_f32 v[18:19], v[18:19], s[38:39], v[6:7] op_sel:[0,0,1] op_sel_hi:[1,0,1]
    v_cvt_pk_bf16_f32 v196, v12, v13
    v_cvt_pk_bf16_f32 v197, v14, v15
    v_cvt_pk_bf16_f32 v198, v16, v17
    v_cvt_pk_bf16_f32 v199, v18, v19
    buffer_store_dwordx4 v[196:199], v0, s[8:11], s35 offen sc1
    v_lshlrev_b32 v12, 16, v200
    v_and_b32 v13, s42, v200
    v_lshlrev_b32 v14, 16, v201
    v_and_b32 v15, s42, v201
    v_lshlrev_b32 v16, 16, v202
    v_and_b32 v17, s42, v202
    v_lshlrev_b32 v18, 16, v203
    v_and_b32 v19, s42, v203
    v_pk_fma_f32 v[12:13], v[12:13], s[38:39], v[6:7] op_sel:[0,0,1] op_sel_hi:[1,0,1]
    v_pk_fma_f32 v[14:15], v[14:15], s[38:39], v[6:7] op_sel:[0,0,1] op_sel_hi:[1,0,1]
    v_pk_fma_f32 v[16:17], v[16:17], s[38:39], v[6:7] op_sel:[0,0,1] op_sel_hi:[1,0,1]
    v_pk_fma_f32 v[18:19], v[18:19], s[38:39], v[6:7] op_sel:[0,0,1] op_sel_hi:[1,0,1]
    v_cvt_pk_bf16_f32 v200, v12, v13
    v_cvt_pk_bf16_f32 v201, v14, v15
    v_cvt_pk_bf16_f32 v202, v16, v17
    v_cvt_pk_bf16_f32 v203, v18, v19
    buffer_store_dwordx4 v[200:203], v0, s[8:11], s35 offen offset:1024 sc1
    s_add_u32 s35, s35, 131072
    v_readlane_b32 s40, v5, 14
    v_readlane_b32 s36, v4, 14
    s_nop 0
    v_mov_b32 v6, s40
    v_lshlrev_b32 v12, 16, v204
    v_and_b32 v13, s42, v204
    v_lshlrev_b32 v14, 16, v205
    v_and_b32 v15, s42, v205
    v_lshlrev_b32 v16, 16, v206
    v_and_b32 v17, s42, v206
    v_lshlrev_b32 v18, 16, v207
    v_and_b32 v19, s42, v207
    v_pk_fma_f32 v[12:13], v[12:13], s[36:37], v[6:7] op_sel_hi:[1,0,0]
    v_pk_fma_f32 v[14:15], v[14:15], s[36:37], v[6:7] op_sel_hi:[1,0,0]
    v_pk_fma_f32 v[16:17], v[16:17], s[36:37], v[6:7] op_sel_hi:[1,0,0]
    v_pk_fma_f32 v[18:19], v[18:19], s[36:37], v[6:7] op_sel_hi:[1,0,0]
    v_cvt_pk_bf16_f32 v204, v12, v13
    v_cvt_pk_bf16_f32 v205, v14, v15
    v_cvt_pk_bf16_f32 v206, v16, v17
    v_cvt_pk_bf16_f32 v207, v18, v19
    buffer_store_dwordx4 v[204:207], v1, s[8:11], s35 offen sc1
    s_add_u32 s35, s35, 131072
    v_readlane_b32 s40, v5, 15
    v_readlane_b32 s38, v4, 15
    s_nop 0
    v_mov_b32 v7, s40
    v_lshlrev_b32 v12, 16, v208
    v_and_b32 v13, s42, v208
    v_lshlrev_b32 v14, 16, v209
    v_and_b32 v15, s42, v209
    v_lshlrev_b32 v16, 16, v210
    v_and_b32 v17, s42, v210
    v_lshlrev_b32 v18, 16, v211
    v_and_b32 v19, s42, v211
    v_pk_fma_f32 v[12:13], v[12:13], s[38:39], v[6:7] op_sel:[0,0,1] op_sel_hi:[1,0,1]
    v_pk_fma_f32 v[14:15], v[14:15], s[38:39], v[6:7] op_sel:[0,0,1] op_sel_hi:[1,0,1]
    v_pk_fma_f32 v[16:17], v[16:17], s[38:39], v[6:7] op_sel:[0,0,1] op_sel_hi:[1,0,1]
    v_pk_fma_f32 v[18:19], v[18:19], s[38:39], v[6:7] op_sel:[0,0,1] op_sel_hi:[1,0,1]
    v_cvt_pk_bf16_f32 v208, v12, v13
    v_cvt_pk_bf16_f32 v209, v14, v15
    v_cvt_pk_bf16_f32 v210, v16, v17
    v_cvt_pk_bf16_f32 v211, v18, v19
    buffer_store_dwordx4 v[208:211], v1, s[8:11], s35 offen sc1
    s_add_u32 s35, s35, 131072
    v_readlane_b32 s40, v5, 16
    v_readlane_b32 s36, v4, 16
    s_nop 0
    v_mov_b32 v6, s40
    v_lshlrev_b32 v12, 16, v212
    v_and_b32 v13, s42, v212
    v_lshlrev_b32 v14, 16, v213
    v_and_b32 v15, s42, v213
    v_lshlrev_b32 v16, 16, v214
    v_and_b32 v17, s42, v214
    v_lshlrev_b32 v18, 16, v215
    v_and_b32 v19, s42, v215
    v_pk_fma_f32 v[12:13], v[12:13], s[36:37], v[6:7] op_sel_hi:[1,0,0]
    v_pk_fma_f32 v[14:15], v[14:15], s[36:37], v[6:7] op_sel_hi:[1,0,0]
    v_pk_fma_f32 v[16:17], v[16:17], s[36:37], v[6:7] op_sel_hi:[1,0,0]
    v_pk_fma_f32 v[18:19], v[18:19], s[36:37], v[6:7] op_sel_hi:[1,0,0]
    v_cvt_pk_bf16_f32 v212, v12, v13
    v_cvt_pk_bf16_f32 v213, v14, v15
    v_cvt_pk_bf16_f32 v214, v16, v17
    v_cvt_pk_bf16_f32 v215, v18, v19
    buffer_store_dwordx4 v[212:215], v1, s[8:11], s35 offen sc1
    s_add_u32 s35, s35, 131072
    v_readlane_b32 s40, v5, 17
    v_readlane_b32 s38, v4, 17
    s_nop 0
    v_mov_b32 v7, s40
    v_lshlrev_b32 v12, 16, v216
    v_and_b32 v13, s42, v216
    v_lshlrev_b32 v14, 16, v217
    v_and_b32 v15, s42, v217
    v_lshlrev_b32 v16, 16, v218
    v_and_b32 v17, s42, v218
    v_lshlrev_b32 v18, 16, v219
    v_and_b32 v19, s42, v219
    v_pk_fma_f32 v[12:13], v[12:13], s[38:39], v[6:7] op_sel:[0,0,1] op_sel_hi:[1,0,1]
    v_pk_fma_f32 v[14:15], v[14:15], s[38:39], v[6:7] op_sel:[0,0,1] op_sel_hi:[1,0,1]
    v_pk_fma_f32 v[16:17], v[16:17], s[38:39], v[6:7] op_sel:[0,0,1] op_sel_hi:[1,0,1]
    v_pk_fma_f32 v[18:19], v[18:19], s[38:39], v[6:7] op_sel:[0,0,1] op_sel_hi:[1,0,1]
    v_cvt_pk_bf16_f32 v216, v12, v13
    v_cvt_pk_bf16_f32 v217, v14, v15
    v_cvt_pk_bf16_f32 v218, v16, v17
    v_cvt_pk_bf16_f32 v219, v18, v19
    buffer_store_dwordx4 v[216:219], v1, s[8:11], s35 offen sc1
L_end:
    s_endpgm
.section .rodata,"a"
.p2align 6
.amdhsa_kernel standalone__groupnorm__prompt_kernel
  .amdhsa_next_free_vgpr 256
  .amdhsa_next_free_sgpr 72
  .amdhsa_accum_offset 256
  .amdhsa_group_segment_fixed_size 0
  .amdhsa_kernarg_size 48
  .amdhsa_user_sgpr_count 2
  .amdhsa_user_sgpr_kernarg_segment_ptr 1
  .amdhsa_system_sgpr_workgroup_id_x 1
  .amdhsa_float_denorm_mode_32 3
.end_amdhsa_kernel
```
